```python
import torch

def _softmax(x, axis=-1):
    return torch.softmax(x, dim=axis)

def _gelu(x):
    return torch.nn.functional.gelu(x, approximate='tanh')

def _silu(x):
    return torch.nn.functional.silu(x)

def _sigmoid(x):
    return torch.sigmoid(x)

def _layernorm(x, axis=-1, eps=1e-05):
    m = x.mean(dim=axis, keepdim=True)
    v = x.var(dim=axis, keepdim=True, unbiased=False)
    return (x - m) / torch.sqrt(v + eps)

def _scatter_add(tgt, idx, src, axis=0):
    return tgt.clone().index_add_(axis, idx, src)

def _segment_sum(src, seg, n):
    out = torch.zeros((n,) + src.shape[1:], dtype=src.dtype)
    return out.index_add_(0, seg, src)

def _pad(x, pw):
    flat = tuple((v for pair in reversed(pw) for v in pair))
    return torch.nn.functional.pad(x, flat)
kernel_name = 'standalone__autoregressive_conv_wavernn__speech'

def setup_inputs():

    _w = lambda a: (lambda t: t.to(torch.bfloat16) if t.is_floating_point() else t)(torch.as_tensor(a))
    B, T, D, K = (2, 4000, 256, 5)
    return {'x': _w((lambda *s: torch.randn(*s, dtype=torch.bfloat16) * 0.1)(B, T, D)), 'w': _w((lambda *s: torch.randn(*s, dtype=torch.bfloat16) * 0.1)(K, D, 2 * D))}

def reference(x, w):
    B, T, D = x.shape
    K = w.shape[0]
    dil = 2
    pad = (K - 1) * dil
    xp = _pad(x, ((0, 0), (pad, 0), (0, 0)))
    h = torch.einsum('btd,de->bte', xp[:, 0:T, :], w[0])
    for i in range(1, K):
        h = h + torch.einsum('btd,de->bte', xp[:, i * dil:i * dil + T, :], w[i])
    f, g = (h[..., :D].clone(), h[..., D:].clone())
    return torch.tanh(f) * _sigmoid(g)
```

```asm
; @launch grid=(256,1,1) block=(512,1,1) lds=163840
.amdgcn_target "amdgcn-amd-amdhsa--gfx950"
.text
.p2align 12
.fill 832, 4, 0xbf810000
.globl standalone__autoregressive_conv_wavernn__speech_kernel
.p2align 8
.type standalone__autoregressive_conv_wavernn__speech_kernel,@function
standalone__autoregressive_conv_wavernn__speech_kernel:
    s_load_dwordx2 s[16:17], s[0:1], 8
    s_load_dwordx2 s[12:13], s[0:1], 0
    v_readfirstlane_b32 s3, v0
    s_lshr_b32 s28, s2, 8
    s_cbranch_scc1 L_end0
    s_bitcmp1_b32 s3, 8
    s_cbranch_scc1 L_consumer
    v_lshrrev_b32 v2, 3, v0
    v_lshrrev_b32 v4, 4, v0
    s_and_b32 s20, s2, 3
    s_lshr_b32 s21, s2, 5
    v_bfi_b32 v4, 6, v2, v4
    s_mul_i32 s31, s21, 5
    s_lshl3_add_u32 s21, s20, s21
    v_xor_b32 v4, v4, v0
    s_lshl_b32 s21, s21, 16
    v_bfi_b32 v4, 14, v4, v0
    s_addk_i32 s21, 0xf000
    v_and_b32 v6, 7, v4
    s_andn2_b32 s20, 1, s2
    s_lshl_b32 s22, s20, 7
    s_lshl_b32 s23, s20, 16
    v_lshrrev_b32 v7, 3, v4
    s_and_b32 s24, s2, 24
    s_lshl4_add_u32 s23, s24, s23
    v_lshlrev_b32 v7, 9, v7
    s_mov_b32 s14, 2048000
    s_bitcmp1_b32 s2, 2
    s_cselect_b32 s24, s14, 0
    v_lshl_add_u32 v5, v6, 4, v7
    s_lshl_b32 s15, 1, 17
    s_lshl_b32 s19, 1, 17
    s_lshl_b32 s18, 5, 18
    v_and_b32 v1, 7, v0
    s_movk_i32 s28, 16384
    s_lshl_b32 s36, 5, 13
    s_lshr_b32 s38, s2, 3
    v_lshlrev_b32 v8, 7, v1
    s_lshl1_add_u32 s38, s38, s22
    v_lshl_add_u32 v8, v2, 18, v8
    s_add_u32 s38, s38, 64
    s_lshl_b32 s38, s38, 9
    v_lshl_add_u32 v1, v1, 4, s21
    s_lshr_b32 s25, s3, 6
    s_and_b32 s31, s31, -8
    s_add_u32 s27, s25, s31
    s_lshl_b32 s27, s27, 10
    s_add_u32 s27, s27, s36
    s_lshl_b32 s31, s31, 15
    s_mulk_i32 s25, 1040
    v_lshl_add_u32 v3, v2, 9, v1
    v_add_u32 v10, s28, v5
    s_add_u32 s26, s23, s31
    s_mov_b32 s29, s26
    s_getpc_b64 s[32:33]
L_pc2:
    s_add_u32 s32, s32, L_sched-L_pc2
    s_addc_u32 s33, s33, 0
    s_waitcnt lgkmcnt(0)
    s_add_u32 s12, s12, s24
    s_addc_u32 s13, s13, 0
L_x:
    s_mov_b32 m0, s25
    v_mov_b32 v7, v3
    s_mov_b32 s30, 3
L_xl:
    buffer_load_dwordx4 v7, s[12:15], s22 offen nt lds
    s_addk_i32 m0, 4160
    v_add_u32 v7, s28, v7
    s_sub_u32 s30, s30, 1
    s_cbranch_scc0 L_xl
    s_cmp_lg_u32 s3, 0
    s_cbranch_scc1 L_x5
    s_nop 0
    buffer_load_dwordx4 v7, s[12:15], s22 offen nt lds
L_x5:
    s_xor_b32 s25, s25, 20480
    s_addk_i32 s22, 128
    s_bitset0_b32 s22, 9
    s_setpc_b64 s[32:33]
L_w:
    s_mov_b32 m0, s27
L_wl:
    buffer_load_dwordx4 v5, s[16:19], s29 offen  lds
    s_addk_i32 m0, 4096
    s_lshl4_add_u32 s37, s28, s29
    buffer_load_dwordx4 v10, s[16:19], s29 offen  lds
    s_addk_i32 m0, 4096
    s_sub_u32 s29, s37, s18
    s_cselect_b32 s29, s37, s29
    s_cselect_b32 s37, 0, s36
    s_sub_u32 m0, m0, s37
    s_cmp_lg_u32 s29, s26
    s_cbranch_scc1 L_wn
    s_add_u32 m0, m0, s36
    s_lshl1_add_u32 s23, s28, s23
    s_bitset0_b32 s23, 18
    s_add_u32 s26, s23, s31
    s_mov_b32 s29, s26
L_wn:
    s_sub_u32 s30, s30, 1
    s_cbranch_scc0 L_wl
    s_mov_b32 s27, m0
    s_setpc_b64 s[32:33]
L_sched:
    s_mov_b32 s30, 0
    s_call_b64 s[32:33], L_w
    s_cmp_eq_u32 s3, 0
    s_cbranch_scc0 L_h1
    buffer_load_dword v12, v8, s[16:19], s38 offen
L_h1:
    s_mov_b32 s30, 5
    s_call_b64 s[32:33], L_w
    s_waitcnt vmcnt(10)
    s_barrier
    s_mov_b32 s30, 2
    s_call_b64 s[32:33], L_w
    s_waitcnt vmcnt(10)
    s_barrier
    s_call_b64 s[32:33], L_x
    s_mov_b32 s30, 0
    s_call_b64 s[32:33], L_w
    s_cmp_eq_u32 s3, 0
    s_waitcnt vmcnt(7)
    s_cbranch_scc1 L_h2
    s_waitcnt vmcnt(6)
L_h2:
    s_barrier
    s_mov_b32 s30, 3
    s_call_b64 s[32:33], L_w
    s_cmp_eq_u32 s3, 0
    s_cbranch_scc0 L_h3
    v_and_b32 v9, 3, v0
    v_lshrrev_b32 v13, 2, v0
    v_lshlrev_b32 v9, 7, v9
    v_lshl_add_u32 v9, v13, 18, v9
    s_lshr_b32 s37, s2, 1
    s_addk_i32 s37, 384
    s_lshl_b32 s37, s37, 9
    s_bitcmp0_b32 s2, 0
    s_cselect_b32 s37, s37, s38
    buffer_load_dword v12, v9, s[16:19], s37 offen
L_h3:
    s_sub_u32 s27, s27, 122880
    s_mov_b32 s30, 2
    s_call_b64 s[32:33], L_w
    s_cmp_eq_u32 s3, 0
    s_waitcnt vmcnt(7)
    s_cbranch_scc1 L_h4
    s_waitcnt vmcnt(6)
L_h4:
    s_barrier
    s_mov_b32 s30, 1
    s_call_b64 s[32:33], L_w
    s_call_b64 s[32:33], L_x
    s_mov_b32 s30, 1
    s_call_b64 s[32:33], L_w
    s_cmp_eq_u32 s3, 0
    s_waitcnt vmcnt(9)
    s_cbranch_scc1 L_h5
    s_waitcnt vmcnt(8)
L_h5:
    s_barrier
    s_mov_b32 s30, 6
    s_call_b64 s[32:33], L_w
    s_waitcnt vmcnt(8)
    s_barrier
    s_mov_b32 s30, 0
    s_call_b64 s[32:33], L_w
    s_call_b64 s[32:33], L_x
    s_sub_u32 s27, s27, 122880
    s_mov_b32 s30, 2
    s_call_b64 s[32:33], L_w
    s_cmp_eq_u32 s3, 0
    s_waitcnt vmcnt(11)
    s_cbranch_scc1 L_h6
    s_waitcnt vmcnt(10)
L_h6:
    s_barrier
    s_mov_b32 s30, 1
    s_call_b64 s[32:33], L_w
    s_mov_b32 s30, 2
    s_call_b64 s[32:33], L_w
    s_waitcnt vmcnt(6)
    s_barrier
    s_mov_b32 s30, 1
    s_call_b64 s[32:33], L_w
    s_load_dwordx2 s[8:9], s[0:1], 16
    v_lshrrev_b32 v14, 5, v0
    v_and_b32 v15, 3, v2
    v_lshl_add_u32 v15, v14, 4, v15
    v_xor_b32 v14, v14, v0
    v_and_b32 v14, 7, v14
    v_lshlrev_b32 v14, 4, v14
    v_lshl_add_u32 v14, v15, 7, v14
    v_add_u32 v14, 122880, v14
    v_and_b32 v16, 7, v0
    v_lshlrev_b32 v16, 4, v16
    v_lshl_add_u32 v15, v15, 9, v16
    s_and_b32 s4, s2, 24
    s_lshl4_add_u32 s4, s4, s21
    s_addk_i32 s4, 4096
    v_add_u32 v15, s4, v15
    s_mov_b32 s10, s14
    s_mov_b32 s11, s15
    s_mov_b32 s30, 3
    s_movk_i32 s5, 512
    s_movk_i32 s6, 2048
    s_waitcnt lgkmcnt(0)
    s_add_u32 s8, s8, s24
    s_addc_u32 s9, s9, 0
    s_waitcnt vmcnt(0)
    s_barrier
L_o:
    s_barrier
    ds_read_b128 v[16:19], v14
    v_add_u32 v14, s5, v14
    s_sub_u32 s30, s30, 1
    s_waitcnt lgkmcnt(0)
    buffer_store_dwordx4 v[16:19], v15, s[8:11], 0 offen sc1
    v_add_u32 v15, s6, v15
    s_cbranch_scc0 L_o
    s_endpgm
L_end0:
    s_endpgm
L_ldend:

L_consumer:
    s_getpc_b64 s[34:35]
L_pcw:
    s_lshr_b32 s24, s2, 3
    s_lshl_b32 s24, s24, 9
    s_lshl1_add_u32 s24, s3, s24
    s_sub_u32 s34, s34, L_pcw-standalone__autoregressive_conv_wavernn__speech_kernel
    s_subb_u32 s35, s35, 0
    s_load_dwordx2 s[46:47], s[34:35], s24 offset:60
    s_addk_i32 s24, 0x4000
    s_min_u32 s24, s24, (L_cend-standalone__autoregressive_conv_wavernn__speech_kernel-68)&0xffffff80
    s_load_dwordx2 s[46:47], s[34:35], s24 offset:60
    s_lshr_b32 s4, s2, 5
    s_mul_i32 s4, s4, 5
    s_lshr_b32 s4, s4, 3
    s_mul_i32 s4, s4, 2048
    s_add_u32 s4, s4, L_v0-standalone__autoregressive_conv_wavernn__speech_kernel
    s_add_u32 s4, s4, s34
    s_addc_u32 s5, s35, 0
    s_mov_b64 vcc, -1
    s_bitcmp1_b32 s3, 7
    s_cbranch_scc1 L_pv0
    s_bitcmp1_b32 s3, 6
    s_cbranch_scc1 L_pad0
    s_setpc_b64 s[4:5]
L_pv0:
    s_bitcmp1_b32 s3, 6
    s_cbranch_scc1 L_pad2
    s_branch L_pad1
L_padret0:
    s_mov_b64 vcc, 0
    v_and_b32 v0, 63, v0
    s_bfe_u32 s29, s3, 0x20006
    v_and_b32 v2, 15, v0
    v_lshrrev_b32 v3, 4, v0
    v_lshrrev_b32 v4, 1, v2
    v_and_b32 v5, 1, v2
    v_mul_u32_u24 v6, 2080, v4
    v_lshl_add_u32 v6, v5, 7, v6
    v_lshl_add_u32 v240, v3, 4, v6
    v_bfe_u32 v6, v0, 2, 2
    v_lshl_add_u32 v7, v3, 3, v6
    v_lshlrev_b32 v7, 8, v7
    v_xor_b32 v8, s29, v6
    v_lshl_add_u32 v7, v8, 5, v7
    v_and_b32 v9, 1, v3
    v_lshl_add_u32 v7, v9, 7, v7
    v_and_b32 v8, 3, v0
    v_lshl_add_u32 v7, v8, 3, v7
    v_add_u32 v241, 40960, v7
    v_xor_b32 v7, 0x80, v7
    v_add_u32 v242, 40960, v7
    v_lshl_add_u32 v6, v4, 4, v5
    v_lshrrev_b32 v8, 1, v3
    v_lshl_add_u32 v8, s29, 1, v8
    v_xor_b32 v8, v8, v4
    v_lshlrev_b32 v8, 4, v8
    v_lshl_add_u32 v6, v6, 7, v8
    v_lshl_add_u32 v243, v9, 3, v6
    v_add_u32 v243, 122880, v243
    s_mov_b32 s42, 40960
    s_mov_b32 s43, 4294885376
    s_mov_b32 s39, 0xc038aa3b
    s_mov_b32 s41, 0x4c000000
    v_mov_b32 v244, 0xc1d00000
    s_setreg_imm32_b32 hwreg(HW_REG_MODE, 8, 1), 0
    s_mov_b32 s40, 0xbfb8aa3b
    s_mov_b32 s30, s39
    s_mov_b32 s31, s39
    s_mov_b32 s32, s40
    s_mov_b32 s33, s40
    s_mov_b32 s34, s41
    s_mov_b32 s35, s41
    s_setprio 3
    s_setpc_b64 s[4:5]
.fill 175, 4, 0xbf810000
L_v0:
    s_cbranch_vccnz L_padret0
    s_barrier
    ds_read_b64_tr_b16 v[96:97], v241 offset:0
    ds_read_b64_tr_b16 v[98:99], v241 offset:1024
    ds_read_b128 v[0:3], v240 offset:0
    ds_read_b64_tr_b16 v[100:101], v242 offset:0
    ds_read_b64_tr_b16 v[102:103], v242 offset:1024
    ds_read_b128 v[4:7], v240 offset:256
    s_waitcnt lgkmcnt(3)
    v_mfma_f32_16x16x32_bf16 v[176:179], v[96:99], v[0:3], 0
    ds_read_b128 v[8:11], v240 offset:512
    ds_read_b64_tr_b16 v[104:105], v241 offset:8192
    s_waitcnt lgkmcnt(3)
    v_mfma_f32_16x16x32_bf16 v[180:183], v[100:103], v[0:3], 0
    ds_read_b64_tr_b16 v[106:107], v241 offset:9216
    ds_read_b64_tr_b16 v[108:109], v242 offset:8192
    s_waitcnt lgkmcnt(4)
    v_mfma_f32_16x16x32_bf16 v[184:187], v[96:99], v[4:7], 0
    ds_read_b64_tr_b16 v[110:111], v242 offset:9216
    ds_read_b128 v[12:15], v240 offset:768
    v_mfma_f32_16x16x32_bf16 v[188:191], v[100:103], v[4:7], 0
    ds_read_b128 v[16:19], v240 offset:1040
    s_waitcnt lgkmcnt(6)
    v_mfma_f32_16x16x32_bf16 v[192:195], v[96:99], v[8:11], 0
    ds_read_b128 v[20:23], v240 offset:1296
    v_mfma_f32_16x16x32_bf16 v[196:199], v[100:103], v[8:11], 0
    ds_read_b128 v[24:27], v240 offset:1552
    s_waitcnt lgkmcnt(6)
    v_mfma_f32_16x16x32_bf16 v[176:179], v[104:107], v[4:7], v[176:179]
    ds_read_b128 v[28:31], v240 offset:1808
    v_mfma_f32_16x16x32_bf16 v[184:187], v[104:107], v[8:11], v[184:187]
    ds_read_b128 v[32:35], v240 offset:2080
    s_waitcnt lgkmcnt(6)
    v_mfma_f32_16x16x32_bf16 v[180:183], v[108:111], v[4:7], v[180:183]
    ds_read_b128 v[36:39], v240 offset:2336
    v_mfma_f32_16x16x32_bf16 v[188:191], v[108:111], v[8:11], v[188:191]
    ds_read_b128 v[40:43], v240 offset:2592
    s_waitcnt lgkmcnt(7)
    v_mfma_f32_16x16x32_bf16 v[192:195], v[104:107], v[12:15], v[192:195]
    ds_read_b128 v[44:47], v240 offset:2848
    v_mfma_f32_16x16x32_bf16 v[196:199], v[108:111], v[12:15], v[196:199]
    ds_read_b128 v[48:51], v240 offset:64
    v_mfma_f32_16x16x32_bf16 v[200:203], v[96:99], v[12:15], 0
    ds_read_b128 v[52:55], v240 offset:320
    v_mfma_f32_16x16x32_bf16 v[204:207], v[100:103], v[12:15], 0
    ds_read_b128 v[56:59], v240 offset:576
    s_waitcnt lgkmcnt(10)
    v_mfma_f32_16x16x32_bf16 v[200:203], v[104:107], v[16:19], v[200:203]
    ds_read_b128 v[60:63], v240 offset:832
    v_mfma_f32_16x16x32_bf16 v[204:207], v[108:111], v[16:19], v[204:207]
    ds_read_b128 v[64:67], v240 offset:1104
    v_mfma_f32_16x16x32_bf16 v[208:211], v[96:99], v[16:19], 0
    ds_read_b128 v[68:71], v240 offset:1360
    v_mfma_f32_16x16x32_bf16 v[212:215], v[100:103], v[16:19], 0
    ds_read_b128 v[72:75], v240 offset:1616
    s_waitcnt lgkmcnt(13)
    v_mfma_f32_16x16x32_bf16 v[208:211], v[104:107], v[20:23], v[208:211]
    ds_read_b128 v[76:79], v240 offset:1872
    v_mfma_f32_16x16x32_bf16 v[212:215], v[108:111], v[20:23], v[212:215]
    ds_read_b128 v[80:83], v240 offset:2144
    v_mfma_f32_16x16x32_bf16 v[216:219], v[96:99], v[20:23], 0
    ds_read_b128 v[84:87], v240 offset:2400
    v_mfma_f32_16x16x32_bf16 v[220:223], v[100:103], v[20:23], 0
    ds_read_b128 v[88:91], v240 offset:2656
    s_waitcnt lgkmcnt(15)
    v_mfma_f32_16x16x32_bf16 v[216:219], v[104:107], v[24:27], v[216:219]
    ds_read_b128 v[92:95], v240 offset:2912
    v_mfma_f32_16x16x32_bf16 v[220:223], v[108:111], v[24:27], v[220:223]
    s_barrier
    v_mfma_f32_16x16x32_bf16 v[224:227], v[96:99], v[24:27], 0
    ds_read_b64_tr_b16 v[112:113], v241 offset:16384
    ds_read_b64_tr_b16 v[114:115], v241 offset:17408
    v_mfma_f32_16x16x32_bf16 v[228:231], v[100:103], v[24:27], 0
    ds_read_b64_tr_b16 v[120:121], v241 offset:24576
    ds_read_b64_tr_b16 v[122:123], v241 offset:25600
    v_mfma_f32_16x16x32_bf16 v[224:227], v[104:107], v[28:31], v[224:227]
    ds_read_b64_tr_b16 v[128:129], v241 offset:32768
    ds_read_b64_tr_b16 v[130:131], v241 offset:33792
    v_mfma_f32_16x16x32_bf16 v[228:231], v[108:111], v[28:31], v[228:231]
    ds_read_b64_tr_b16 v[116:117], v242 offset:16384
    v_mfma_f32_16x16x32_bf16 v[232:235], v[96:99], v[28:31], 0
    ds_read_b64_tr_b16 v[118:119], v242 offset:17408
    v_mfma_f32_16x16x32_bf16 v[236:239], v[100:103], v[28:31], 0
    ds_read_b64_tr_b16 v[124:125], v242 offset:24576
    s_waitcnt lgkmcnt(15)
    v_mfma_f32_16x16x32_bf16 v[232:235], v[104:107], v[32:35], v[232:235]
    ds_read_b64_tr_b16 v[126:127], v242 offset:25600
    v_mfma_f32_16x16x32_bf16 v[236:239], v[108:111], v[32:35], v[236:239]
    ds_read_b64_tr_b16 v[132:133], v242 offset:32768
    s_waitcnt lgkmcnt(9)
    v_mfma_f32_16x16x32_bf16 v[176:179], v[112:115], v[8:11], v[176:179]
    ds_read_b64_tr_b16 v[134:135], v242 offset:33792
    s_waitcnt lgkmcnt(8)
    v_mfma_f32_16x16x32_bf16 v[176:179], v[120:123], v[12:15], v[176:179]
    v_add_u32 v241, s42, v241
    s_waitcnt lgkmcnt(6)
    v_mfma_f32_16x16x32_bf16 v[176:179], v[128:131], v[16:19], v[176:179]
    v_add_u32 v242, s42, v242
    v_mfma_f32_16x16x32_bf16 v[184:187], v[128:131], v[20:23], v[184:187]
    v_mfma_f32_16x16x32_bf16 v[184:187], v[120:123], v[16:19], v[184:187]
    v_mfma_f32_16x16x32_bf16 v[184:187], v[112:115], v[12:15], v[184:187]
    v_mfma_f32_16x16x32_bf16 v[192:195], v[112:115], v[16:19], v[192:195]
    v_mfma_f32_16x16x32_bf16 v[192:195], v[120:123], v[20:23], v[192:195]
    v_mfma_f32_16x16x32_bf16 v[192:195], v[128:131], v[24:27], v[192:195]
    v_mfma_f32_16x16x32_bf16 v[200:203], v[128:131], v[28:31], v[200:203]
    v_mfma_f32_16x16x32_bf16 v[200:203], v[120:123], v[24:27], v[200:203]
    v_mfma_f32_16x16x32_bf16 v[200:203], v[112:115], v[20:23], v[200:203]
    v_mfma_f32_16x16x32_bf16 v[208:211], v[112:115], v[24:27], v[208:211]
    v_mfma_f32_16x16x32_bf16 v[208:211], v[120:123], v[28:31], v[208:211]
    v_mfma_f32_16x16x32_bf16 v[208:211], v[128:131], v[32:35], v[208:211]
    v_mfma_f32_16x16x32_bf16 v[216:219], v[128:131], v[36:39], v[216:219]
    v_mfma_f32_16x16x32_bf16 v[216:219], v[120:123], v[32:35], v[216:219]
    v_mfma_f32_16x16x32_bf16 v[216:219], v[112:115], v[28:31], v[216:219]
    v_mfma_f32_16x16x32_bf16 v[224:227], v[112:115], v[32:35], v[224:227]
    v_mfma_f32_16x16x32_bf16 v[224:227], v[120:123], v[36:39], v[224:227]
    v_mfma_f32_16x16x32_bf16 v[224:227], v[128:131], v[40:43], v[224:227]
    v_mfma_f32_16x16x32_bf16 v[232:235], v[128:131], v[44:47], v[232:235]
    v_mfma_f32_16x16x32_bf16 v[232:235], v[120:123], v[40:43], v[232:235]
    v_mfma_f32_16x16x32_bf16 v[232:235], v[112:115], v[36:39], v[232:235]
    s_waitcnt lgkmcnt(4)
    v_mfma_f32_16x16x32_bf16 v[180:183], v[116:119], v[8:11], v[180:183]
    s_waitcnt lgkmcnt(2)
    v_mfma_f32_16x16x32_bf16 v[180:183], v[124:127], v[12:15], v[180:183]
    s_waitcnt lgkmcnt(0)
    v_mfma_f32_16x16x32_bf16 v[180:183], v[132:135], v[16:19], v[180:183]
    v_mfma_f32_16x16x32_bf16 v[188:191], v[132:135], v[20:23], v[188:191]
    v_mfma_f32_16x16x32_bf16 v[188:191], v[124:127], v[16:19], v[188:191]
    v_mfma_f32_16x16x32_bf16 v[188:191], v[116:119], v[12:15], v[188:191]
    v_mfma_f32_16x16x32_bf16 v[196:199], v[116:119], v[16:19], v[196:199]
    v_mfma_f32_16x16x32_bf16 v[196:199], v[124:127], v[20:23], v[196:199]
    v_mfma_f32_16x16x32_bf16 v[196:199], v[132:135], v[24:27], v[196:199]
    v_mfma_f32_16x16x32_bf16 v[204:207], v[132:135], v[28:31], v[204:207]
    s_barrier
    v_mfma_f32_16x16x32_bf16 v[204:207], v[124:127], v[24:27], v[204:207]
    ds_read_b64_tr_b16 v[136:137], v241 offset:0
    v_mfma_f32_16x16x32_bf16 v[204:207], v[116:119], v[20:23], v[204:207]
    ds_read_b64_tr_b16 v[138:139], v241 offset:1024
    v_mfma_f32_16x16x32_bf16 v[212:215], v[116:119], v[24:27], v[212:215]
    ds_read_b64_tr_b16 v[144:145], v241 offset:8192
    v_mfma_f32_16x16x32_bf16 v[212:215], v[124:127], v[28:31], v[212:215]
    ds_read_b64_tr_b16 v[146:147], v241 offset:9216
    v_mfma_f32_16x16x32_bf16 v[212:215], v[132:135], v[32:35], v[212:215]
    ds_read_b64_tr_b16 v[152:153], v241 offset:16384
    v_mfma_f32_16x16x32_bf16 v[220:223], v[132:135], v[36:39], v[220:223]
    ds_read_b64_tr_b16 v[154:155], v241 offset:17408
    v_mfma_f32_16x16x32_bf16 v[220:223], v[124:127], v[32:35], v[220:223]
    ds_read_b64_tr_b16 v[160:161], v241 offset:24576
    v_mfma_f32_16x16x32_bf16 v[220:223], v[116:119], v[28:31], v[220:223]
    ds_read_b64_tr_b16 v[162:163], v241 offset:25600
    v_mfma_f32_16x16x32_bf16 v[228:231], v[116:119], v[32:35], v[228:231]
    ds_read_b64_tr_b16 v[168:169], v241 offset:32768
    v_mfma_f32_16x16x32_bf16 v[228:231], v[124:127], v[36:39], v[228:231]
    ds_read_b64_tr_b16 v[170:171], v241 offset:33792
    v_mfma_f32_16x16x32_bf16 v[228:231], v[132:135], v[40:43], v[228:231]
    ds_read_b64_tr_b16 v[140:141], v242 offset:0
    v_mfma_f32_16x16x32_bf16 v[236:239], v[132:135], v[44:47], v[236:239]
    ds_read_b64_tr_b16 v[142:143], v242 offset:1024
    v_mfma_f32_16x16x32_bf16 v[236:239], v[124:127], v[40:43], v[236:239]
    ds_read_b64_tr_b16 v[148:149], v242 offset:8192
    v_mfma_f32_16x16x32_bf16 v[236:239], v[116:119], v[36:39], v[236:239]
    ds_read_b64_tr_b16 v[150:151], v242 offset:9216
    s_branch L_merge
.fill 212, 4, 0xbf810000
L_v1:
    s_cbranch_vccnz L_padret0
    s_barrier
    ds_read_b64_tr_b16 v[104:105], v241 offset:8192
    ds_read_b64_tr_b16 v[106:107], v241 offset:9216
    ds_read_b128 v[4:7], v240 offset:256
    ds_read_b64_tr_b16 v[108:109], v242 offset:8192
    ds_read_b64_tr_b16 v[110:111], v242 offset:9216
    ds_read_b128 v[8:11], v240 offset:512
    s_waitcnt lgkmcnt(3)
    v_mfma_f32_16x16x32_bf16 v[176:179], v[104:107], v[4:7], 0
    ds_read_b128 v[12:15], v240 offset:768
    ds_read_b64_tr_b16 v[112:113], v241 offset:16384
    s_waitcnt lgkmcnt(3)
    v_mfma_f32_16x16x32_bf16 v[180:183], v[108:111], v[4:7], 0
    ds_read_b64_tr_b16 v[114:115], v241 offset:17408
    ds_read_b64_tr_b16 v[116:117], v242 offset:16384
    s_waitcnt lgkmcnt(4)
    v_mfma_f32_16x16x32_bf16 v[184:187], v[104:107], v[8:11], 0
    ds_read_b64_tr_b16 v[118:119], v242 offset:17408
    ds_read_b128 v[16:19], v240 offset:1040
    v_mfma_f32_16x16x32_bf16 v[188:191], v[108:111], v[8:11], 0
    ds_read_b128 v[20:23], v240 offset:1296
    s_waitcnt lgkmcnt(6)
    v_mfma_f32_16x16x32_bf16 v[192:195], v[104:107], v[12:15], 0
    ds_read_b128 v[24:27], v240 offset:1552
    v_mfma_f32_16x16x32_bf16 v[196:199], v[108:111], v[12:15], 0
    ds_read_b128 v[28:31], v240 offset:1808
    s_waitcnt lgkmcnt(6)
    v_mfma_f32_16x16x32_bf16 v[176:179], v[112:115], v[8:11], v[176:179]
    ds_read_b128 v[32:35], v240 offset:2080
    v_mfma_f32_16x16x32_bf16 v[184:187], v[112:115], v[12:15], v[184:187]
    ds_read_b128 v[36:39], v240 offset:2336
    s_waitcnt lgkmcnt(6)
    v_mfma_f32_16x16x32_bf16 v[180:183], v[116:119], v[8:11], v[180:183]
    ds_read_b128 v[0:3], v240 offset:0
    v_mfma_f32_16x16x32_bf16 v[188:191], v[116:119], v[12:15], v[188:191]
    ds_read_b128 v[40:43], v240 offset:2592
    s_waitcnt lgkmcnt(7)
    v_mfma_f32_16x16x32_bf16 v[192:195], v[112:115], v[16:19], v[192:195]
    ds_read_b128 v[44:47], v240 offset:2848
    v_mfma_f32_16x16x32_bf16 v[196:199], v[116:119], v[16:19], v[196:199]
    ds_read_b128 v[48:51], v240 offset:64
    v_mfma_f32_16x16x32_bf16 v[200:203], v[104:107], v[16:19], 0
    ds_read_b128 v[52:55], v240 offset:320
    v_mfma_f32_16x16x32_bf16 v[204:207], v[108:111], v[16:19], 0
    ds_read_b128 v[56:59], v240 offset:576
    s_waitcnt lgkmcnt(10)
    v_mfma_f32_16x16x32_bf16 v[200:203], v[112:115], v[20:23], v[200:203]
    ds_read_b128 v[60:63], v240 offset:832
    v_mfma_f32_16x16x32_bf16 v[204:207], v[116:119], v[20:23], v[204:207]
    ds_read_b128 v[64:67], v240 offset:1104
    v_mfma_f32_16x16x32_bf16 v[208:211], v[104:107], v[20:23], 0
    ds_read_b128 v[68:71], v240 offset:1360
    v_mfma_f32_16x16x32_bf16 v[212:215], v[108:111], v[20:23], 0
    ds_read_b128 v[72:75], v240 offset:1616
    s_waitcnt lgkmcnt(13)
    v_mfma_f32_16x16x32_bf16 v[208:211], v[112:115], v[24:27], v[208:211]
    ds_read_b128 v[76:79], v240 offset:1872
    v_mfma_f32_16x16x32_bf16 v[212:215], v[116:119], v[24:27], v[212:215]
    ds_read_b128 v[80:83], v240 offset:2144
    v_mfma_f32_16x16x32_bf16 v[216:219], v[104:107], v[24:27], 0
    ds_read_b128 v[84:87], v240 offset:2400
    v_mfma_f32_16x16x32_bf16 v[220:223], v[108:111], v[24:27], 0
    ds_read_b128 v[88:91], v240 offset:2656
    s_waitcnt lgkmcnt(15)
    v_mfma_f32_16x16x32_bf16 v[216:219], v[112:115], v[28:31], v[216:219]
    ds_read_b128 v[92:95], v240 offset:2912
    v_mfma_f32_16x16x32_bf16 v[220:223], v[116:119], v[28:31], v[220:223]
    s_barrier
    v_mfma_f32_16x16x32_bf16 v[224:227], v[104:107], v[28:31], 0
    ds_read_b64_tr_b16 v[120:121], v241 offset:24576
    ds_read_b64_tr_b16 v[122:123], v241 offset:25600
    v_mfma_f32_16x16x32_bf16 v[228:231], v[108:111], v[28:31], 0
    ds_read_b64_tr_b16 v[128:129], v241 offset:32768
    ds_read_b64_tr_b16 v[130:131], v241 offset:33792
    v_mfma_f32_16x16x32_bf16 v[224:227], v[112:115], v[32:35], v[224:227]
    ds_read_b64_tr_b16 v[96:97], v241 offset:0
    ds_read_b64_tr_b16 v[98:99], v241 offset:1024
    v_mfma_f32_16x16x32_bf16 v[228:231], v[116:119], v[32:35], v[228:231]
    ds_read_b64_tr_b16 v[124:125], v242 offset:24576
    v_mfma_f32_16x16x32_bf16 v[232:235], v[104:107], v[32:35], 0
    ds_read_b64_tr_b16 v[126:127], v242 offset:25600
    v_mfma_f32_16x16x32_bf16 v[236:239], v[108:111], v[32:35], 0
    ds_read_b64_tr_b16 v[132:133], v242 offset:32768
    s_waitcnt lgkmcnt(15)
    v_mfma_f32_16x16x32_bf16 v[232:235], v[112:115], v[36:39], v[232:235]
    ds_read_b64_tr_b16 v[134:135], v242 offset:33792
    v_mfma_f32_16x16x32_bf16 v[236:239], v[116:119], v[36:39], v[236:239]
    ds_read_b64_tr_b16 v[100:101], v242 offset:0
    s_waitcnt lgkmcnt(9)
    v_mfma_f32_16x16x32_bf16 v[176:179], v[120:123], v[12:15], v[176:179]
    ds_read_b64_tr_b16 v[102:103], v242 offset:1024
    s_waitcnt lgkmcnt(8)
    v_mfma_f32_16x16x32_bf16 v[176:179], v[128:131], v[16:19], v[176:179]
    v_add_u32 v241, s42, v241
    s_waitcnt lgkmcnt(6)
    v_mfma_f32_16x16x32_bf16 v[176:179], v[96:99], v[0:3], v[176:179]
    v_add_u32 v242, s42, v242
    v_mfma_f32_16x16x32_bf16 v[184:187], v[96:99], v[4:7], v[184:187]
    v_mfma_f32_16x16x32_bf16 v[184:187], v[128:131], v[20:23], v[184:187]
    v_mfma_f32_16x16x32_bf16 v[184:187], v[120:123], v[16:19], v[184:187]
    v_mfma_f32_16x16x32_bf16 v[192:195], v[120:123], v[20:23], v[192:195]
    v_mfma_f32_16x16x32_bf16 v[192:195], v[128:131], v[24:27], v[192:195]
    v_mfma_f32_16x16x32_bf16 v[192:195], v[96:99], v[8:11], v[192:195]
    v_mfma_f32_16x16x32_bf16 v[200:203], v[96:99], v[12:15], v[200:203]
    v_mfma_f32_16x16x32_bf16 v[200:203], v[128:131], v[28:31], v[200:203]
    v_mfma_f32_16x16x32_bf16 v[200:203], v[120:123], v[24:27], v[200:203]
    v_mfma_f32_16x16x32_bf16 v[208:211], v[120:123], v[28:31], v[208:211]
    v_mfma_f32_16x16x32_bf16 v[208:211], v[128:131], v[32:35], v[208:211]
    v_mfma_f32_16x16x32_bf16 v[208:211], v[96:99], v[16:19], v[208:211]
    v_mfma_f32_16x16x32_bf16 v[216:219], v[96:99], v[20:23], v[216:219]
    v_mfma_f32_16x16x32_bf16 v[216:219], v[128:131], v[36:39], v[216:219]
    v_mfma_f32_16x16x32_bf16 v[216:219], v[120:123], v[32:35], v[216:219]
    v_mfma_f32_16x16x32_bf16 v[224:227], v[120:123], v[36:39], v[224:227]
    v_mfma_f32_16x16x32_bf16 v[224:227], v[128:131], v[40:43], v[224:227]
    v_mfma_f32_16x16x32_bf16 v[224:227], v[96:99], v[24:27], v[224:227]
    v_mfma_f32_16x16x32_bf16 v[232:235], v[96:99], v[28:31], v[232:235]
    v_mfma_f32_16x16x32_bf16 v[232:235], v[128:131], v[44:47], v[232:235]
    v_mfma_f32_16x16x32_bf16 v[232:235], v[120:123], v[40:43], v[232:235]
    s_waitcnt lgkmcnt(4)
    v_mfma_f32_16x16x32_bf16 v[180:183], v[124:127], v[12:15], v[180:183]
    s_waitcnt lgkmcnt(2)
    v_mfma_f32_16x16x32_bf16 v[180:183], v[132:135], v[16:19], v[180:183]
    s_waitcnt lgkmcnt(0)
    v_mfma_f32_16x16x32_bf16 v[180:183], v[100:103], v[0:3], v[180:183]
    v_mfma_f32_16x16x32_bf16 v[188:191], v[100:103], v[4:7], v[188:191]
    v_mfma_f32_16x16x32_bf16 v[188:191], v[132:135], v[20:23], v[188:191]
    v_mfma_f32_16x16x32_bf16 v[188:191], v[124:127], v[16:19], v[188:191]
    v_mfma_f32_16x16x32_bf16 v[196:199], v[124:127], v[20:23], v[196:199]
    v_mfma_f32_16x16x32_bf16 v[196:199], v[132:135], v[24:27], v[196:199]
    v_mfma_f32_16x16x32_bf16 v[196:199], v[100:103], v[8:11], v[196:199]
    v_mfma_f32_16x16x32_bf16 v[204:207], v[100:103], v[12:15], v[204:207]
    s_barrier
    v_mfma_f32_16x16x32_bf16 v[204:207], v[132:135], v[28:31], v[204:207]
    ds_read_b64_tr_b16 v[136:137], v241 offset:0
    v_mfma_f32_16x16x32_bf16 v[204:207], v[124:127], v[24:27], v[204:207]
    ds_read_b64_tr_b16 v[138:139], v241 offset:1024
    v_mfma_f32_16x16x32_bf16 v[212:215], v[124:127], v[28:31], v[212:215]
    ds_read_b64_tr_b16 v[144:145], v241 offset:8192
    v_mfma_f32_16x16x32_bf16 v[212:215], v[132:135], v[32:35], v[212:215]
    ds_read_b64_tr_b16 v[146:147], v241 offset:9216
    v_mfma_f32_16x16x32_bf16 v[212:215], v[100:103], v[16:19], v[212:215]
    ds_read_b64_tr_b16 v[152:153], v241 offset:16384
    v_mfma_f32_16x16x32_bf16 v[220:223], v[100:103], v[20:23], v[220:223]
    ds_read_b64_tr_b16 v[154:155], v241 offset:17408
    v_mfma_f32_16x16x32_bf16 v[220:223], v[132:135], v[36:39], v[220:223]
    ds_read_b64_tr_b16 v[160:161], v241 offset:24576
    v_mfma_f32_16x16x32_bf16 v[220:223], v[124:127], v[32:35], v[220:223]
    ds_read_b64_tr_b16 v[162:163], v241 offset:25600
    v_mfma_f32_16x16x32_bf16 v[228:231], v[124:127], v[36:39], v[228:231]
    ds_read_b64_tr_b16 v[168:169], v241 offset:32768
    v_mfma_f32_16x16x32_bf16 v[228:231], v[132:135], v[40:43], v[228:231]
    ds_read_b64_tr_b16 v[170:171], v241 offset:33792
    v_mfma_f32_16x16x32_bf16 v[228:231], v[100:103], v[24:27], v[228:231]
    ds_read_b64_tr_b16 v[140:141], v242 offset:0
    v_mfma_f32_16x16x32_bf16 v[236:239], v[100:103], v[28:31], v[236:239]
    ds_read_b64_tr_b16 v[142:143], v242 offset:1024
    v_mfma_f32_16x16x32_bf16 v[236:239], v[132:135], v[44:47], v[236:239]
    ds_read_b64_tr_b16 v[148:149], v242 offset:8192
    v_mfma_f32_16x16x32_bf16 v[236:239], v[124:127], v[40:43], v[236:239]
    ds_read_b64_tr_b16 v[150:151], v242 offset:9216
    s_branch L_merge
.fill 212, 4, 0xbf810000
L_v2:
    s_cbranch_vccnz L_padret0
    s_barrier
    ds_read_b64_tr_b16 v[112:113], v241 offset:16384
    ds_read_b64_tr_b16 v[114:115], v241 offset:17408
    ds_read_b128 v[8:11], v240 offset:512
    ds_read_b64_tr_b16 v[116:117], v242 offset:16384
    ds_read_b64_tr_b16 v[118:119], v242 offset:17408
    ds_read_b128 v[12:15], v240 offset:768
    s_waitcnt lgkmcnt(3)
    v_mfma_f32_16x16x32_bf16 v[176:179], v[112:115], v[8:11], 0
    ds_read_b128 v[16:19], v240 offset:1040
    ds_read_b64_tr_b16 v[120:121], v241 offset:24576
    s_waitcnt lgkmcnt(3)
    v_mfma_f32_16x16x32_bf16 v[180:183], v[116:119], v[8:11], 0
    ds_read_b64_tr_b16 v[122:123], v241 offset:25600
    ds_read_b64_tr_b16 v[124:125], v242 offset:24576
    s_waitcnt lgkmcnt(4)
    v_mfma_f32_16x16x32_bf16 v[184:187], v[112:115], v[12:15], 0
    ds_read_b64_tr_b16 v[126:127], v242 offset:25600
    ds_read_b128 v[20:23], v240 offset:1296
    v_mfma_f32_16x16x32_bf16 v[188:191], v[116:119], v[12:15], 0
    ds_read_b128 v[24:27], v240 offset:1552
    s_waitcnt lgkmcnt(6)
    v_mfma_f32_16x16x32_bf16 v[192:195], v[112:115], v[16:19], 0
    ds_read_b128 v[28:31], v240 offset:1808
    v_mfma_f32_16x16x32_bf16 v[196:199], v[116:119], v[16:19], 0
    ds_read_b128 v[32:35], v240 offset:2080
    s_waitcnt lgkmcnt(6)
    v_mfma_f32_16x16x32_bf16 v[176:179], v[120:123], v[12:15], v[176:179]
    ds_read_b128 v[36:39], v240 offset:2336
    v_mfma_f32_16x16x32_bf16 v[184:187], v[120:123], v[16:19], v[184:187]
    ds_read_b128 v[40:43], v240 offset:2592
    s_waitcnt lgkmcnt(6)
    v_mfma_f32_16x16x32_bf16 v[180:183], v[124:127], v[12:15], v[180:183]
    ds_read_b128 v[0:3], v240 offset:0
    v_mfma_f32_16x16x32_bf16 v[188:191], v[124:127], v[16:19], v[188:191]
    ds_read_b128 v[4:7], v240 offset:256
    s_waitcnt lgkmcnt(7)
    v_mfma_f32_16x16x32_bf16 v[192:195], v[120:123], v[20:23], v[192:195]
    ds_read_b128 v[44:47], v240 offset:2848
    v_mfma_f32_16x16x32_bf16 v[196:199], v[124:127], v[20:23], v[196:199]
    ds_read_b128 v[48:51], v240 offset:64
    v_mfma_f32_16x16x32_bf16 v[200:203], v[112:115], v[20:23], 0
    ds_read_b128 v[52:55], v240 offset:320
    v_mfma_f32_16x16x32_bf16 v[204:207], v[116:119], v[20:23], 0
    ds_read_b128 v[56:59], v240 offset:576
    s_waitcnt lgkmcnt(10)
    v_mfma_f32_16x16x32_bf16 v[200:203], v[120:123], v[24:27], v[200:203]
    ds_read_b128 v[60:63], v240 offset:832
    v_mfma_f32_16x16x32_bf16 v[204:207], v[124:127], v[24:27], v[204:207]
    ds_read_b128 v[64:67], v240 offset:1104
    v_mfma_f32_16x16x32_bf16 v[208:211], v[112:115], v[24:27], 0
    ds_read_b128 v[68:71], v240 offset:1360
    v_mfma_f32_16x16x32_bf16 v[212:215], v[116:119], v[24:27], 0
    ds_read_b128 v[72:75], v240 offset:1616
    s_waitcnt lgkmcnt(13)
    v_mfma_f32_16x16x32_bf16 v[208:211], v[120:123], v[28:31], v[208:211]
    ds_read_b128 v[76:79], v240 offset:1872
    v_mfma_f32_16x16x32_bf16 v[212:215], v[124:127], v[28:31], v[212:215]
    ds_read_b128 v[80:83], v240 offset:2144
    v_mfma_f32_16x16x32_bf16 v[216:219], v[112:115], v[28:31], 0
    ds_read_b128 v[84:87], v240 offset:2400
    v_mfma_f32_16x16x32_bf16 v[220:223], v[116:119], v[28:31], 0
    ds_read_b128 v[88:91], v240 offset:2656
    s_waitcnt lgkmcnt(15)
    v_mfma_f32_16x16x32_bf16 v[216:219], v[120:123], v[32:35], v[216:219]
    ds_read_b128 v[92:95], v240 offset:2912
    v_mfma_f32_16x16x32_bf16 v[220:223], v[124:127], v[32:35], v[220:223]
    s_barrier
    v_mfma_f32_16x16x32_bf16 v[224:227], v[112:115], v[32:35], 0
    ds_read_b64_tr_b16 v[128:129], v241 offset:32768
    ds_read_b64_tr_b16 v[130:131], v241 offset:33792
    v_mfma_f32_16x16x32_bf16 v[228:231], v[116:119], v[32:35], 0
    ds_read_b64_tr_b16 v[96:97], v241 offset:0
    ds_read_b64_tr_b16 v[98:99], v241 offset:1024
    v_mfma_f32_16x16x32_bf16 v[224:227], v[120:123], v[36:39], v[224:227]
    ds_read_b64_tr_b16 v[104:105], v241 offset:8192
    ds_read_b64_tr_b16 v[106:107], v241 offset:9216
    v_mfma_f32_16x16x32_bf16 v[228:231], v[124:127], v[36:39], v[228:231]
    ds_read_b64_tr_b16 v[132:133], v242 offset:32768
    v_mfma_f32_16x16x32_bf16 v[232:235], v[112:115], v[36:39], 0
    ds_read_b64_tr_b16 v[134:135], v242 offset:33792
    v_mfma_f32_16x16x32_bf16 v[236:239], v[116:119], v[36:39], 0
    ds_read_b64_tr_b16 v[100:101], v242 offset:0
    s_waitcnt lgkmcnt(15)
    v_mfma_f32_16x16x32_bf16 v[232:235], v[120:123], v[40:43], v[232:235]
    ds_read_b64_tr_b16 v[102:103], v242 offset:1024
    v_mfma_f32_16x16x32_bf16 v[236:239], v[124:127], v[40:43], v[236:239]
    ds_read_b64_tr_b16 v[108:109], v242 offset:8192
    s_waitcnt lgkmcnt(9)
    v_mfma_f32_16x16x32_bf16 v[176:179], v[128:131], v[16:19], v[176:179]
    ds_read_b64_tr_b16 v[110:111], v242 offset:9216
    s_waitcnt lgkmcnt(8)
    v_mfma_f32_16x16x32_bf16 v[176:179], v[96:99], v[0:3], v[176:179]
    v_add_u32 v241, s42, v241
    s_waitcnt lgkmcnt(6)
    v_mfma_f32_16x16x32_bf16 v[176:179], v[104:107], v[4:7], v[176:179]
    v_add_u32 v242, s42, v242
    v_mfma_f32_16x16x32_bf16 v[184:187], v[104:107], v[8:11], v[184:187]
    v_mfma_f32_16x16x32_bf16 v[184:187], v[96:99], v[4:7], v[184:187]
    v_mfma_f32_16x16x32_bf16 v[184:187], v[128:131], v[20:23], v[184:187]
    v_mfma_f32_16x16x32_bf16 v[192:195], v[128:131], v[24:27], v[192:195]
    v_mfma_f32_16x16x32_bf16 v[192:195], v[96:99], v[8:11], v[192:195]
    v_mfma_f32_16x16x32_bf16 v[192:195], v[104:107], v[12:15], v[192:195]
    v_mfma_f32_16x16x32_bf16 v[200:203], v[104:107], v[16:19], v[200:203]
    v_mfma_f32_16x16x32_bf16 v[200:203], v[96:99], v[12:15], v[200:203]
    v_mfma_f32_16x16x32_bf16 v[200:203], v[128:131], v[28:31], v[200:203]
    v_mfma_f32_16x16x32_bf16 v[208:211], v[128:131], v[32:35], v[208:211]
    v_mfma_f32_16x16x32_bf16 v[208:211], v[96:99], v[16:19], v[208:211]
    v_mfma_f32_16x16x32_bf16 v[208:211], v[104:107], v[20:23], v[208:211]
    v_mfma_f32_16x16x32_bf16 v[216:219], v[104:107], v[24:27], v[216:219]
    v_mfma_f32_16x16x32_bf16 v[216:219], v[96:99], v[20:23], v[216:219]
    v_mfma_f32_16x16x32_bf16 v[216:219], v[128:131], v[36:39], v[216:219]
    v_mfma_f32_16x16x32_bf16 v[224:227], v[128:131], v[40:43], v[224:227]
    v_mfma_f32_16x16x32_bf16 v[224:227], v[96:99], v[24:27], v[224:227]
    v_mfma_f32_16x16x32_bf16 v[224:227], v[104:107], v[28:31], v[224:227]
    v_mfma_f32_16x16x32_bf16 v[232:235], v[104:107], v[32:35], v[232:235]
    v_mfma_f32_16x16x32_bf16 v[232:235], v[96:99], v[28:31], v[232:235]
    v_mfma_f32_16x16x32_bf16 v[232:235], v[128:131], v[44:47], v[232:235]
    s_waitcnt lgkmcnt(4)
    v_mfma_f32_16x16x32_bf16 v[180:183], v[132:135], v[16:19], v[180:183]
    s_waitcnt lgkmcnt(2)
    v_mfma_f32_16x16x32_bf16 v[180:183], v[100:103], v[0:3], v[180:183]
    s_waitcnt lgkmcnt(0)
    v_mfma_f32_16x16x32_bf16 v[180:183], v[108:111], v[4:7], v[180:183]
    v_mfma_f32_16x16x32_bf16 v[188:191], v[108:111], v[8:11], v[188:191]
    v_mfma_f32_16x16x32_bf16 v[188:191], v[100:103], v[4:7], v[188:191]
    v_mfma_f32_16x16x32_bf16 v[188:191], v[132:135], v[20:23], v[188:191]
    v_mfma_f32_16x16x32_bf16 v[196:199], v[132:135], v[24:27], v[196:199]
    v_mfma_f32_16x16x32_bf16 v[196:199], v[100:103], v[8:11], v[196:199]
    v_mfma_f32_16x16x32_bf16 v[196:199], v[108:111], v[12:15], v[196:199]
    v_mfma_f32_16x16x32_bf16 v[204:207], v[108:111], v[16:19], v[204:207]
    s_barrier
    v_mfma_f32_16x16x32_bf16 v[204:207], v[100:103], v[12:15], v[204:207]
    ds_read_b64_tr_b16 v[136:137], v241 offset:0
    v_mfma_f32_16x16x32_bf16 v[204:207], v[132:135], v[28:31], v[204:207]
    ds_read_b64_tr_b16 v[138:139], v241 offset:1024
    v_mfma_f32_16x16x32_bf16 v[212:215], v[132:135], v[32:35], v[212:215]
    ds_read_b64_tr_b16 v[144:145], v241 offset:8192
    v_mfma_f32_16x16x32_bf16 v[212:215], v[100:103], v[16:19], v[212:215]
    ds_read_b64_tr_b16 v[146:147], v241 offset:9216
    v_mfma_f32_16x16x32_bf16 v[212:215], v[108:111], v[20:23], v[212:215]
    ds_read_b64_tr_b16 v[152:153], v241 offset:16384
    v_mfma_f32_16x16x32_bf16 v[220:223], v[108:111], v[24:27], v[220:223]
    ds_read_b64_tr_b16 v[154:155], v241 offset:17408
    v_mfma_f32_16x16x32_bf16 v[220:223], v[100:103], v[20:23], v[220:223]
    ds_read_b64_tr_b16 v[160:161], v241 offset:24576
    v_mfma_f32_16x16x32_bf16 v[220:223], v[132:135], v[36:39], v[220:223]
    ds_read_b64_tr_b16 v[162:163], v241 offset:25600
    v_mfma_f32_16x16x32_bf16 v[228:231], v[132:135], v[40:43], v[228:231]
    ds_read_b64_tr_b16 v[168:169], v241 offset:32768
    v_mfma_f32_16x16x32_bf16 v[228:231], v[100:103], v[24:27], v[228:231]
    ds_read_b64_tr_b16 v[170:171], v241 offset:33792
    v_mfma_f32_16x16x32_bf16 v[228:231], v[108:111], v[28:31], v[228:231]
    ds_read_b64_tr_b16 v[140:141], v242 offset:0
    v_mfma_f32_16x16x32_bf16 v[236:239], v[108:111], v[32:35], v[236:239]
    ds_read_b64_tr_b16 v[142:143], v242 offset:1024
    v_mfma_f32_16x16x32_bf16 v[236:239], v[100:103], v[28:31], v[236:239]
    ds_read_b64_tr_b16 v[148:149], v242 offset:8192
    v_mfma_f32_16x16x32_bf16 v[236:239], v[132:135], v[44:47], v[236:239]
    ds_read_b64_tr_b16 v[150:151], v242 offset:9216
    s_branch L_merge
.fill 212, 4, 0xbf810000
L_v3:
    s_cbranch_vccnz L_padret0
    s_barrier
    ds_read_b64_tr_b16 v[120:121], v241 offset:24576
    ds_read_b64_tr_b16 v[122:123], v241 offset:25600
    ds_read_b128 v[12:15], v240 offset:768
    ds_read_b64_tr_b16 v[124:125], v242 offset:24576
    ds_read_b64_tr_b16 v[126:127], v242 offset:25600
    ds_read_b128 v[16:19], v240 offset:1040
    s_waitcnt lgkmcnt(3)
    v_mfma_f32_16x16x32_bf16 v[176:179], v[120:123], v[12:15], 0
    ds_read_b128 v[20:23], v240 offset:1296
    ds_read_b64_tr_b16 v[128:129], v241 offset:32768
    s_waitcnt lgkmcnt(3)
    v_mfma_f32_16x16x32_bf16 v[180:183], v[124:127], v[12:15], 0
    ds_read_b64_tr_b16 v[130:131], v241 offset:33792
    ds_read_b64_tr_b16 v[132:133], v242 offset:32768
    s_waitcnt lgkmcnt(4)
    v_mfma_f32_16x16x32_bf16 v[184:187], v[120:123], v[16:19], 0
    ds_read_b64_tr_b16 v[134:135], v242 offset:33792
    ds_read_b128 v[24:27], v240 offset:1552
    v_mfma_f32_16x16x32_bf16 v[188:191], v[124:127], v[16:19], 0
    ds_read_b128 v[28:31], v240 offset:1808
    s_waitcnt lgkmcnt(6)
    v_mfma_f32_16x16x32_bf16 v[192:195], v[120:123], v[20:23], 0
    ds_read_b128 v[32:35], v240 offset:2080
    v_mfma_f32_16x16x32_bf16 v[196:199], v[124:127], v[20:23], 0
    ds_read_b128 v[36:39], v240 offset:2336
    s_waitcnt lgkmcnt(6)
    v_mfma_f32_16x16x32_bf16 v[176:179], v[128:131], v[16:19], v[176:179]
    ds_read_b128 v[40:43], v240 offset:2592
    v_mfma_f32_16x16x32_bf16 v[184:187], v[128:131], v[20:23], v[184:187]
    ds_read_b128 v[44:47], v240 offset:2848
    s_waitcnt lgkmcnt(6)
    v_mfma_f32_16x16x32_bf16 v[180:183], v[132:135], v[16:19], v[180:183]
    ds_read_b128 v[0:3], v240 offset:0
    v_mfma_f32_16x16x32_bf16 v[188:191], v[132:135], v[20:23], v[188:191]
    ds_read_b128 v[4:7], v240 offset:256
    s_waitcnt lgkmcnt(7)
    v_mfma_f32_16x16x32_bf16 v[192:195], v[128:131], v[24:27], v[192:195]
    ds_read_b128 v[8:11], v240 offset:512
    v_mfma_f32_16x16x32_bf16 v[196:199], v[132:135], v[24:27], v[196:199]
    ds_read_b128 v[48:51], v240 offset:64
    v_mfma_f32_16x16x32_bf16 v[200:203], v[120:123], v[24:27], 0
    ds_read_b128 v[52:55], v240 offset:320
    v_mfma_f32_16x16x32_bf16 v[204:207], v[124:127], v[24:27], 0
    ds_read_b128 v[56:59], v240 offset:576
    s_waitcnt lgkmcnt(10)
    v_mfma_f32_16x16x32_bf16 v[200:203], v[128:131], v[28:31], v[200:203]
    ds_read_b128 v[60:63], v240 offset:832
    v_mfma_f32_16x16x32_bf16 v[204:207], v[132:135], v[28:31], v[204:207]
    ds_read_b128 v[64:67], v240 offset:1104
    v_mfma_f32_16x16x32_bf16 v[208:211], v[120:123], v[28:31], 0
    ds_read_b128 v[68:71], v240 offset:1360
    v_mfma_f32_16x16x32_bf16 v[212:215], v[124:127], v[28:31], 0
    ds_read_b128 v[72:75], v240 offset:1616
    s_waitcnt lgkmcnt(13)
    v_mfma_f32_16x16x32_bf16 v[208:211], v[128:131], v[32:35], v[208:211]
    ds_read_b128 v[76:79], v240 offset:1872
    v_mfma_f32_16x16x32_bf16 v[212:215], v[132:135], v[32:35], v[212:215]
    ds_read_b128 v[80:83], v240 offset:2144
    v_mfma_f32_16x16x32_bf16 v[216:219], v[120:123], v[32:35], 0
    ds_read_b128 v[84:87], v240 offset:2400
    v_mfma_f32_16x16x32_bf16 v[220:223], v[124:127], v[32:35], 0
    ds_read_b128 v[88:91], v240 offset:2656
    s_waitcnt lgkmcnt(15)
    v_mfma_f32_16x16x32_bf16 v[216:219], v[128:131], v[36:39], v[216:219]
    ds_read_b128 v[92:95], v240 offset:2912
    v_mfma_f32_16x16x32_bf16 v[220:223], v[132:135], v[36:39], v[220:223]
    s_barrier
    v_mfma_f32_16x16x32_bf16 v[224:227], v[120:123], v[36:39], 0
    ds_read_b64_tr_b16 v[96:97], v241 offset:0
    ds_read_b64_tr_b16 v[98:99], v241 offset:1024
    v_mfma_f32_16x16x32_bf16 v[228:231], v[124:127], v[36:39], 0
    ds_read_b64_tr_b16 v[104:105], v241 offset:8192
    ds_read_b64_tr_b16 v[106:107], v241 offset:9216
    v_mfma_f32_16x16x32_bf16 v[224:227], v[128:131], v[40:43], v[224:227]
    ds_read_b64_tr_b16 v[112:113], v241 offset:16384
    ds_read_b64_tr_b16 v[114:115], v241 offset:17408
    v_mfma_f32_16x16x32_bf16 v[228:231], v[132:135], v[40:43], v[228:231]
    ds_read_b64_tr_b16 v[100:101], v242 offset:0
    v_mfma_f32_16x16x32_bf16 v[232:235], v[120:123], v[40:43], 0
    ds_read_b64_tr_b16 v[102:103], v242 offset:1024
    v_mfma_f32_16x16x32_bf16 v[236:239], v[124:127], v[40:43], 0
    ds_read_b64_tr_b16 v[108:109], v242 offset:8192
    s_waitcnt lgkmcnt(15)
    v_mfma_f32_16x16x32_bf16 v[232:235], v[128:131], v[44:47], v[232:235]
    ds_read_b64_tr_b16 v[110:111], v242 offset:9216
    v_mfma_f32_16x16x32_bf16 v[236:239], v[132:135], v[44:47], v[236:239]
    ds_read_b64_tr_b16 v[116:117], v242 offset:16384
    s_waitcnt lgkmcnt(9)
    v_mfma_f32_16x16x32_bf16 v[176:179], v[96:99], v[0:3], v[176:179]
    ds_read_b64_tr_b16 v[118:119], v242 offset:17408
    s_waitcnt lgkmcnt(8)
    v_mfma_f32_16x16x32_bf16 v[176:179], v[104:107], v[4:7], v[176:179]
    v_add_u32 v241, s42, v241
    s_waitcnt lgkmcnt(6)
    v_mfma_f32_16x16x32_bf16 v[176:179], v[112:115], v[8:11], v[176:179]
    v_add_u32 v242, s42, v242
    v_mfma_f32_16x16x32_bf16 v[184:187], v[112:115], v[12:15], v[184:187]
    v_mfma_f32_16x16x32_bf16 v[184:187], v[104:107], v[8:11], v[184:187]
    v_mfma_f32_16x16x32_bf16 v[184:187], v[96:99], v[4:7], v[184:187]
    v_mfma_f32_16x16x32_bf16 v[192:195], v[96:99], v[8:11], v[192:195]
    v_mfma_f32_16x16x32_bf16 v[192:195], v[104:107], v[12:15], v[192:195]
    v_mfma_f32_16x16x32_bf16 v[192:195], v[112:115], v[16:19], v[192:195]
    v_mfma_f32_16x16x32_bf16 v[200:203], v[112:115], v[20:23], v[200:203]
    v_mfma_f32_16x16x32_bf16 v[200:203], v[104:107], v[16:19], v[200:203]
    v_mfma_f32_16x16x32_bf16 v[200:203], v[96:99], v[12:15], v[200:203]
    v_mfma_f32_16x16x32_bf16 v[208:211], v[96:99], v[16:19], v[208:211]
    v_mfma_f32_16x16x32_bf16 v[208:211], v[104:107], v[20:23], v[208:211]
    v_mfma_f32_16x16x32_bf16 v[208:211], v[112:115], v[24:27], v[208:211]
    v_mfma_f32_16x16x32_bf16 v[216:219], v[112:115], v[28:31], v[216:219]
    v_mfma_f32_16x16x32_bf16 v[216:219], v[104:107], v[24:27], v[216:219]
    v_mfma_f32_16x16x32_bf16 v[216:219], v[96:99], v[20:23], v[216:219]
    v_mfma_f32_16x16x32_bf16 v[224:227], v[96:99], v[24:27], v[224:227]
    v_mfma_f32_16x16x32_bf16 v[224:227], v[104:107], v[28:31], v[224:227]
    v_mfma_f32_16x16x32_bf16 v[224:227], v[112:115], v[32:35], v[224:227]
    v_mfma_f32_16x16x32_bf16 v[232:235], v[112:115], v[36:39], v[232:235]
    v_mfma_f32_16x16x32_bf16 v[232:235], v[104:107], v[32:35], v[232:235]
    v_mfma_f32_16x16x32_bf16 v[232:235], v[96:99], v[28:31], v[232:235]
    s_waitcnt lgkmcnt(4)
    v_mfma_f32_16x16x32_bf16 v[180:183], v[100:103], v[0:3], v[180:183]
    s_waitcnt lgkmcnt(2)
    v_mfma_f32_16x16x32_bf16 v[180:183], v[108:111], v[4:7], v[180:183]
    s_waitcnt lgkmcnt(0)
    v_mfma_f32_16x16x32_bf16 v[180:183], v[116:119], v[8:11], v[180:183]
    v_mfma_f32_16x16x32_bf16 v[188:191], v[116:119], v[12:15], v[188:191]
    v_mfma_f32_16x16x32_bf16 v[188:191], v[108:111], v[8:11], v[188:191]
    v_mfma_f32_16x16x32_bf16 v[188:191], v[100:103], v[4:7], v[188:191]
    v_mfma_f32_16x16x32_bf16 v[196:199], v[100:103], v[8:11], v[196:199]
    v_mfma_f32_16x16x32_bf16 v[196:199], v[108:111], v[12:15], v[196:199]
    v_mfma_f32_16x16x32_bf16 v[196:199], v[116:119], v[16:19], v[196:199]
    v_mfma_f32_16x16x32_bf16 v[204:207], v[116:119], v[20:23], v[204:207]
    s_barrier
    v_mfma_f32_16x16x32_bf16 v[204:207], v[108:111], v[16:19], v[204:207]
    ds_read_b64_tr_b16 v[136:137], v241 offset:0
    v_mfma_f32_16x16x32_bf16 v[204:207], v[100:103], v[12:15], v[204:207]
    ds_read_b64_tr_b16 v[138:139], v241 offset:1024
    v_mfma_f32_16x16x32_bf16 v[212:215], v[100:103], v[16:19], v[212:215]
    ds_read_b64_tr_b16 v[144:145], v241 offset:8192
    v_mfma_f32_16x16x32_bf16 v[212:215], v[108:111], v[20:23], v[212:215]
    ds_read_b64_tr_b16 v[146:147], v241 offset:9216
    v_mfma_f32_16x16x32_bf16 v[212:215], v[116:119], v[24:27], v[212:215]
    ds_read_b64_tr_b16 v[152:153], v241 offset:16384
    v_mfma_f32_16x16x32_bf16 v[220:223], v[116:119], v[28:31], v[220:223]
    ds_read_b64_tr_b16 v[154:155], v241 offset:17408
    v_mfma_f32_16x16x32_bf16 v[220:223], v[108:111], v[24:27], v[220:223]
    ds_read_b64_tr_b16 v[160:161], v241 offset:24576
    v_mfma_f32_16x16x32_bf16 v[220:223], v[100:103], v[20:23], v[220:223]
    ds_read_b64_tr_b16 v[162:163], v241 offset:25600
    v_mfma_f32_16x16x32_bf16 v[228:231], v[100:103], v[24:27], v[228:231]
    ds_read_b64_tr_b16 v[168:169], v241 offset:32768
    v_mfma_f32_16x16x32_bf16 v[228:231], v[108:111], v[28:31], v[228:231]
    ds_read_b64_tr_b16 v[170:171], v241 offset:33792
    v_mfma_f32_16x16x32_bf16 v[228:231], v[116:119], v[32:35], v[228:231]
    ds_read_b64_tr_b16 v[140:141], v242 offset:0
    v_mfma_f32_16x16x32_bf16 v[236:239], v[116:119], v[36:39], v[236:239]
    ds_read_b64_tr_b16 v[142:143], v242 offset:1024
    v_mfma_f32_16x16x32_bf16 v[236:239], v[108:111], v[32:35], v[236:239]
    ds_read_b64_tr_b16 v[148:149], v242 offset:8192
    v_mfma_f32_16x16x32_bf16 v[236:239], v[100:103], v[28:31], v[236:239]
    ds_read_b64_tr_b16 v[150:151], v242 offset:9216
    s_branch L_merge
.fill 212, 4, 0xbf810000
L_v4:
    s_cbranch_vccnz L_padret0
    s_barrier
    ds_read_b64_tr_b16 v[128:129], v241 offset:32768
    ds_read_b64_tr_b16 v[130:131], v241 offset:33792
    ds_read_b128 v[16:19], v240 offset:1040
    ds_read_b64_tr_b16 v[132:133], v242 offset:32768
    ds_read_b64_tr_b16 v[134:135], v242 offset:33792
    ds_read_b128 v[20:23], v240 offset:1296
    s_waitcnt lgkmcnt(3)
    v_mfma_f32_16x16x32_bf16 v[176:179], v[128:131], v[16:19], 0
    ds_read_b128 v[24:27], v240 offset:1552
    ds_read_b64_tr_b16 v[96:97], v241 offset:0
    s_waitcnt lgkmcnt(3)
    v_mfma_f32_16x16x32_bf16 v[180:183], v[132:135], v[16:19], 0
    ds_read_b64_tr_b16 v[98:99], v241 offset:1024
    ds_read_b64_tr_b16 v[100:101], v242 offset:0
    s_waitcnt lgkmcnt(4)
    v_mfma_f32_16x16x32_bf16 v[184:187], v[128:131], v[20:23], 0
    ds_read_b64_tr_b16 v[102:103], v242 offset:1024
    ds_read_b128 v[28:31], v240 offset:1808
    v_mfma_f32_16x16x32_bf16 v[188:191], v[132:135], v[20:23], 0
    ds_read_b128 v[32:35], v240 offset:2080
    s_waitcnt lgkmcnt(6)
    v_mfma_f32_16x16x32_bf16 v[192:195], v[128:131], v[24:27], 0
    ds_read_b128 v[36:39], v240 offset:2336
    v_mfma_f32_16x16x32_bf16 v[196:199], v[132:135], v[24:27], 0
    ds_read_b128 v[40:43], v240 offset:2592
    s_waitcnt lgkmcnt(6)
    v_mfma_f32_16x16x32_bf16 v[208:211], v[96:99], v[16:19], 0
    ds_read_b128 v[44:47], v240 offset:2848
    v_mfma_f32_16x16x32_bf16 v[216:219], v[96:99], v[20:23], 0
    ds_read_b128 v[0:3], v240 offset:0
    v_mfma_f32_16x16x32_bf16 v[224:227], v[96:99], v[24:27], 0
    ds_read_b128 v[4:7], v240 offset:256
    s_waitcnt lgkmcnt(7)
    v_mfma_f32_16x16x32_bf16 v[212:215], v[100:103], v[16:19], 0
    ds_read_b128 v[8:11], v240 offset:512
    v_mfma_f32_16x16x32_bf16 v[220:223], v[100:103], v[20:23], 0
    ds_read_b128 v[12:15], v240 offset:768
    v_mfma_f32_16x16x32_bf16 v[228:231], v[100:103], v[24:27], 0
    ds_read_b128 v[48:51], v240 offset:64
    s_waitcnt lgkmcnt(9)
    v_mfma_f32_16x16x32_bf16 v[200:203], v[128:131], v[28:31], 0
    ds_read_b128 v[52:55], v240 offset:320
    v_mfma_f32_16x16x32_bf16 v[204:207], v[132:135], v[28:31], 0
    ds_read_b128 v[56:59], v240 offset:576
    v_mfma_f32_16x16x32_bf16 v[232:235], v[96:99], v[28:31], 0
    ds_read_b128 v[60:63], v240 offset:832
    v_mfma_f32_16x16x32_bf16 v[236:239], v[100:103], v[28:31], 0
    ds_read_b128 v[64:67], v240 offset:1104
    s_waitcnt lgkmcnt(12)
    v_mfma_f32_16x16x32_bf16 v[208:211], v[128:131], v[32:35], v[208:211]
    ds_read_b128 v[68:71], v240 offset:1360
    v_mfma_f32_16x16x32_bf16 v[212:215], v[132:135], v[32:35], v[212:215]
    ds_read_b128 v[72:75], v240 offset:1616
    s_waitcnt lgkmcnt(13)
    v_mfma_f32_16x16x32_bf16 v[216:219], v[128:131], v[36:39], v[216:219]
    ds_read_b128 v[76:79], v240 offset:1872
    v_mfma_f32_16x16x32_bf16 v[220:223], v[132:135], v[36:39], v[220:223]
    ds_read_b128 v[80:83], v240 offset:2144
    s_waitcnt lgkmcnt(14)
    v_mfma_f32_16x16x32_bf16 v[224:227], v[128:131], v[40:43], v[224:227]
    ds_read_b128 v[84:87], v240 offset:2400
    v_mfma_f32_16x16x32_bf16 v[228:231], v[132:135], v[40:43], v[228:231]
    ds_read_b128 v[88:91], v240 offset:2656
    s_waitcnt lgkmcnt(15)
    v_mfma_f32_16x16x32_bf16 v[232:235], v[128:131], v[44:47], v[232:235]
    ds_read_b128 v[92:95], v240 offset:2912
    v_mfma_f32_16x16x32_bf16 v[236:239], v[132:135], v[44:47], v[236:239]
    s_barrier
    s_waitcnt lgkmcnt(15)
    v_mfma_f32_16x16x32_bf16 v[176:179], v[96:99], v[0:3], v[176:179]
    ds_read_b64_tr_b16 v[104:105], v241 offset:8192
    ds_read_b64_tr_b16 v[106:107], v241 offset:9216
    v_mfma_f32_16x16x32_bf16 v[180:183], v[100:103], v[0:3], v[180:183]
    ds_read_b64_tr_b16 v[112:113], v241 offset:16384
    ds_read_b64_tr_b16 v[114:115], v241 offset:17408
    s_waitcnt lgkmcnt(15)
    v_mfma_f32_16x16x32_bf16 v[184:187], v[96:99], v[4:7], v[184:187]
    ds_read_b64_tr_b16 v[120:121], v241 offset:24576
    ds_read_b64_tr_b16 v[122:123], v241 offset:25600
    v_mfma_f32_16x16x32_bf16 v[188:191], v[100:103], v[4:7], v[188:191]
    ds_read_b64_tr_b16 v[108:109], v242 offset:8192
    v_mfma_f32_16x16x32_bf16 v[192:195], v[96:99], v[8:11], v[192:195]
    ds_read_b64_tr_b16 v[110:111], v242 offset:9216
    v_mfma_f32_16x16x32_bf16 v[196:199], v[100:103], v[8:11], v[196:199]
    ds_read_b64_tr_b16 v[116:117], v242 offset:16384
    v_mfma_f32_16x16x32_bf16 v[200:203], v[96:99], v[12:15], v[200:203]
    ds_read_b64_tr_b16 v[118:119], v242 offset:17408
    v_mfma_f32_16x16x32_bf16 v[204:207], v[100:103], v[12:15], v[204:207]
    ds_read_b64_tr_b16 v[124:125], v242 offset:24576
    s_waitcnt lgkmcnt(9)
    v_mfma_f32_16x16x32_bf16 v[176:179], v[104:107], v[4:7], v[176:179]
    ds_read_b64_tr_b16 v[126:127], v242 offset:25600
    s_waitcnt lgkmcnt(8)
    v_mfma_f32_16x16x32_bf16 v[176:179], v[112:115], v[8:11], v[176:179]
    v_add_u32 v241, s42, v241
    s_waitcnt lgkmcnt(6)
    v_mfma_f32_16x16x32_bf16 v[176:179], v[120:123], v[12:15], v[176:179]
    v_add_u32 v242, s42, v242
    v_mfma_f32_16x16x32_bf16 v[184:187], v[120:123], v[16:19], v[184:187]
    v_mfma_f32_16x16x32_bf16 v[184:187], v[112:115], v[12:15], v[184:187]
    v_mfma_f32_16x16x32_bf16 v[184:187], v[104:107], v[8:11], v[184:187]
    v_mfma_f32_16x16x32_bf16 v[192:195], v[104:107], v[12:15], v[192:195]
    v_mfma_f32_16x16x32_bf16 v[192:195], v[112:115], v[16:19], v[192:195]
    v_mfma_f32_16x16x32_bf16 v[192:195], v[120:123], v[20:23], v[192:195]
    v_mfma_f32_16x16x32_bf16 v[200:203], v[120:123], v[24:27], v[200:203]
    v_mfma_f32_16x16x32_bf16 v[200:203], v[112:115], v[20:23], v[200:203]
    v_mfma_f32_16x16x32_bf16 v[200:203], v[104:107], v[16:19], v[200:203]
    v_mfma_f32_16x16x32_bf16 v[208:211], v[104:107], v[20:23], v[208:211]
    v_mfma_f32_16x16x32_bf16 v[208:211], v[112:115], v[24:27], v[208:211]
    v_mfma_f32_16x16x32_bf16 v[208:211], v[120:123], v[28:31], v[208:211]
    v_mfma_f32_16x16x32_bf16 v[216:219], v[120:123], v[32:35], v[216:219]
    v_mfma_f32_16x16x32_bf16 v[216:219], v[112:115], v[28:31], v[216:219]
    v_mfma_f32_16x16x32_bf16 v[216:219], v[104:107], v[24:27], v[216:219]
    v_mfma_f32_16x16x32_bf16 v[224:227], v[104:107], v[28:31], v[224:227]
    v_mfma_f32_16x16x32_bf16 v[224:227], v[112:115], v[32:35], v[224:227]
    v_mfma_f32_16x16x32_bf16 v[224:227], v[120:123], v[36:39], v[224:227]
    v_mfma_f32_16x16x32_bf16 v[232:235], v[120:123], v[40:43], v[232:235]
    v_mfma_f32_16x16x32_bf16 v[232:235], v[112:115], v[36:39], v[232:235]
    v_mfma_f32_16x16x32_bf16 v[232:235], v[104:107], v[32:35], v[232:235]
    s_waitcnt lgkmcnt(4)
    v_mfma_f32_16x16x32_bf16 v[180:183], v[108:111], v[4:7], v[180:183]
    s_waitcnt lgkmcnt(2)
    v_mfma_f32_16x16x32_bf16 v[180:183], v[116:119], v[8:11], v[180:183]
    s_waitcnt lgkmcnt(0)
    v_mfma_f32_16x16x32_bf16 v[180:183], v[124:127], v[12:15], v[180:183]
    v_mfma_f32_16x16x32_bf16 v[188:191], v[124:127], v[16:19], v[188:191]
    v_mfma_f32_16x16x32_bf16 v[188:191], v[116:119], v[12:15], v[188:191]
    v_mfma_f32_16x16x32_bf16 v[188:191], v[108:111], v[8:11], v[188:191]
    v_mfma_f32_16x16x32_bf16 v[196:199], v[108:111], v[12:15], v[196:199]
    v_mfma_f32_16x16x32_bf16 v[196:199], v[116:119], v[16:19], v[196:199]
    v_mfma_f32_16x16x32_bf16 v[196:199], v[124:127], v[20:23], v[196:199]
    v_mfma_f32_16x16x32_bf16 v[204:207], v[124:127], v[24:27], v[204:207]
    s_barrier
    v_mfma_f32_16x16x32_bf16 v[204:207], v[116:119], v[20:23], v[204:207]
    ds_read_b64_tr_b16 v[136:137], v241 offset:0
    v_mfma_f32_16x16x32_bf16 v[204:207], v[108:111], v[16:19], v[204:207]
    ds_read_b64_tr_b16 v[138:139], v241 offset:1024
    v_mfma_f32_16x16x32_bf16 v[212:215], v[108:111], v[20:23], v[212:215]
    ds_read_b64_tr_b16 v[144:145], v241 offset:8192
    v_mfma_f32_16x16x32_bf16 v[212:215], v[116:119], v[24:27], v[212:215]
    ds_read_b64_tr_b16 v[146:147], v241 offset:9216
    v_mfma_f32_16x16x32_bf16 v[212:215], v[124:127], v[28:31], v[212:215]
    ds_read_b64_tr_b16 v[152:153], v241 offset:16384
    v_mfma_f32_16x16x32_bf16 v[220:223], v[124:127], v[32:35], v[220:223]
    ds_read_b64_tr_b16 v[154:155], v241 offset:17408
    v_mfma_f32_16x16x32_bf16 v[220:223], v[116:119], v[28:31], v[220:223]
    ds_read_b64_tr_b16 v[160:161], v241 offset:24576
    v_mfma_f32_16x16x32_bf16 v[220:223], v[108:111], v[24:27], v[220:223]
    ds_read_b64_tr_b16 v[162:163], v241 offset:25600
    v_mfma_f32_16x16x32_bf16 v[228:231], v[108:111], v[28:31], v[228:231]
    ds_read_b64_tr_b16 v[168:169], v241 offset:32768
    v_mfma_f32_16x16x32_bf16 v[228:231], v[116:119], v[32:35], v[228:231]
    ds_read_b64_tr_b16 v[170:171], v241 offset:33792
    v_mfma_f32_16x16x32_bf16 v[228:231], v[124:127], v[36:39], v[228:231]
    ds_read_b64_tr_b16 v[140:141], v242 offset:0
    v_mfma_f32_16x16x32_bf16 v[236:239], v[124:127], v[40:43], v[236:239]
    ds_read_b64_tr_b16 v[142:143], v242 offset:1024
    v_mfma_f32_16x16x32_bf16 v[236:239], v[116:119], v[36:39], v[236:239]
    ds_read_b64_tr_b16 v[148:149], v242 offset:8192
    v_mfma_f32_16x16x32_bf16 v[236:239], v[108:111], v[32:35], v[236:239]
    ds_read_b64_tr_b16 v[150:151], v242 offset:9216
L_loop:
L_merge:
L_pad0:
    s_cbranch_vccnz L_padret0
    s_waitcnt lgkmcnt(12)
    v_mfma_f32_16x16x32_bf16 v[176:179], v[136:139], v[48:51], v[176:179]
    ds_read_b64_tr_b16 v[156:157], v242 offset:16384
    s_waitcnt lgkmcnt(11)
    v_mfma_f32_16x16x32_bf16 v[176:179], v[144:147], v[52:55], v[176:179]
    ds_read_b64_tr_b16 v[158:159], v242 offset:17408
    s_waitcnt lgkmcnt(10)
    v_mfma_f32_16x16x32_bf16 v[176:179], v[152:155], v[56:59], v[176:179]
    ds_read_b64_tr_b16 v[164:165], v242 offset:24576
    s_waitcnt lgkmcnt(9)
    v_mfma_f32_16x16x32_bf16 v[176:179], v[160:163], v[60:63], v[176:179]
    ds_read_b64_tr_b16 v[166:167], v242 offset:25600
    s_waitcnt lgkmcnt(8)
    v_mfma_f32_16x16x32_bf16 v[176:179], v[168:171], v[64:67], v[176:179]
    ds_read_b64_tr_b16 v[172:173], v242 offset:32768
    v_mfma_f32_16x16x32_bf16 v[184:187], v[168:171], v[68:71], v[184:187]
    ds_read_b64_tr_b16 v[174:175], v242 offset:33792
    v_mfma_f32_16x16x32_bf16 v[184:187], v[160:163], v[64:67], v[184:187]
    v_add_u32 v241, s42, v241
    v_mfma_f32_16x16x32_bf16 v[184:187], v[152:155], v[60:63], v[184:187]
    v_add_u32 v242, s42, v242
    v_mfma_f32_16x16x32_bf16 v[184:187], v[144:147], v[56:59], v[184:187]
    v_mfma_f32_16x16x32_bf16 v[184:187], v[136:139], v[52:55], v[184:187]
    v_mfma_f32_16x16x32_bf16 v[192:195], v[136:139], v[56:59], v[192:195]
    v_mfma_f32_16x16x32_bf16 v[192:195], v[144:147], v[60:63], v[192:195]
    v_mfma_f32_16x16x32_bf16 v[192:195], v[152:155], v[64:67], v[192:195]
    v_mfma_f32_16x16x32_bf16 v[192:195], v[160:163], v[68:71], v[192:195]
    v_mfma_f32_16x16x32_bf16 v[192:195], v[168:171], v[72:75], v[192:195]
    v_mfma_f32_16x16x32_bf16 v[200:203], v[168:171], v[76:79], v[200:203]
    v_mfma_f32_16x16x32_bf16 v[200:203], v[160:163], v[72:75], v[200:203]
    v_mfma_f32_16x16x32_bf16 v[200:203], v[152:155], v[68:71], v[200:203]
    v_mfma_f32_16x16x32_bf16 v[200:203], v[144:147], v[64:67], v[200:203]
    v_mfma_f32_16x16x32_bf16 v[200:203], v[136:139], v[60:63], v[200:203]
    v_mfma_f32_16x16x32_bf16 v[208:211], v[136:139], v[64:67], v[208:211]
    v_mfma_f32_16x16x32_bf16 v[208:211], v[144:147], v[68:71], v[208:211]
    v_mfma_f32_16x16x32_bf16 v[208:211], v[152:155], v[72:75], v[208:211]
    v_mfma_f32_16x16x32_bf16 v[208:211], v[160:163], v[76:79], v[208:211]
    v_mfma_f32_16x16x32_bf16 v[208:211], v[168:171], v[80:83], v[208:211]
    v_mfma_f32_16x16x32_bf16 v[216:219], v[168:171], v[84:87], v[216:219]
    v_mfma_f32_16x16x32_bf16 v[216:219], v[160:163], v[80:83], v[216:219]
    v_mfma_f32_16x16x32_bf16 v[216:219], v[152:155], v[76:79], v[216:219]
    v_mfma_f32_16x16x32_bf16 v[216:219], v[144:147], v[72:75], v[216:219]
    v_mfma_f32_16x16x32_bf16 v[216:219], v[136:139], v[68:71], v[216:219]
    v_mfma_f32_16x16x32_bf16 v[224:227], v[136:139], v[72:75], v[224:227]
    v_mfma_f32_16x16x32_bf16 v[224:227], v[144:147], v[76:79], v[224:227]
    v_mfma_f32_16x16x32_bf16 v[224:227], v[152:155], v[80:83], v[224:227]
    v_mfma_f32_16x16x32_bf16 v[224:227], v[160:163], v[84:87], v[224:227]
    v_mfma_f32_16x16x32_bf16 v[224:227], v[168:171], v[88:91], v[224:227]
    v_mfma_f32_16x16x32_bf16 v[232:235], v[168:171], v[92:95], v[232:235]
    v_mfma_f32_16x16x32_bf16 v[232:235], v[160:163], v[88:91], v[232:235]
    v_mfma_f32_16x16x32_bf16 v[232:235], v[152:155], v[84:87], v[232:235]
    v_mfma_f32_16x16x32_bf16 v[232:235], v[144:147], v[80:83], v[232:235]
    v_mfma_f32_16x16x32_bf16 v[232:235], v[136:139], v[76:79], v[232:235]
    s_waitcnt lgkmcnt(8)
    v_mfma_f32_16x16x32_bf16 v[180:183], v[140:143], v[48:51], v[180:183]
    s_waitcnt lgkmcnt(6)
    v_mfma_f32_16x16x32_bf16 v[180:183], v[148:151], v[52:55], v[180:183]
    s_waitcnt lgkmcnt(4)
    v_mfma_f32_16x16x32_bf16 v[180:183], v[156:159], v[56:59], v[180:183]
    s_waitcnt lgkmcnt(2)
    v_mfma_f32_16x16x32_bf16 v[180:183], v[164:167], v[60:63], v[180:183]
    s_waitcnt lgkmcnt(0)
    v_mfma_f32_16x16x32_bf16 v[180:183], v[172:175], v[64:67], v[180:183]
    v_mfma_f32_16x16x32_bf16 v[188:191], v[172:175], v[68:71], v[188:191]
    v_mfma_f32_16x16x32_bf16 v[188:191], v[164:167], v[64:67], v[188:191]
    v_mfma_f32_16x16x32_bf16 v[188:191], v[156:159], v[60:63], v[188:191]
    v_mfma_f32_16x16x32_bf16 v[188:191], v[148:151], v[56:59], v[188:191]
    v_mfma_f32_16x16x32_bf16 v[188:191], v[140:143], v[52:55], v[188:191]
    v_mfma_f32_16x16x32_bf16 v[196:199], v[140:143], v[56:59], v[196:199]
    v_mfma_f32_16x16x32_bf16 v[196:199], v[148:151], v[60:63], v[196:199]
    v_mfma_f32_16x16x32_bf16 v[196:199], v[156:159], v[64:67], v[196:199]
    v_mfma_f32_16x16x32_bf16 v[196:199], v[164:167], v[68:71], v[196:199]
    v_mfma_f32_16x16x32_bf16 v[196:199], v[172:175], v[72:75], v[196:199]
    v_mfma_f32_16x16x32_bf16 v[204:207], v[172:175], v[76:79], v[204:207]
    v_mfma_f32_16x16x32_bf16 v[204:207], v[164:167], v[72:75], v[204:207]
    v_mfma_f32_16x16x32_bf16 v[204:207], v[156:159], v[68:71], v[204:207]
    v_mfma_f32_16x16x32_bf16 v[204:207], v[148:151], v[64:67], v[204:207]
    v_mfma_f32_16x16x32_bf16 v[204:207], v[140:143], v[60:63], v[204:207]
    v_mfma_f32_16x16x32_bf16 v[212:215], v[140:143], v[64:67], v[212:215]
    v_mfma_f32_16x16x32_bf16 v[212:215], v[148:151], v[68:71], v[212:215]
    v_mfma_f32_16x16x32_bf16 v[212:215], v[156:159], v[72:75], v[212:215]
    v_mfma_f32_16x16x32_bf16 v[212:215], v[164:167], v[76:79], v[212:215]
    v_mfma_f32_16x16x32_bf16 v[212:215], v[172:175], v[80:83], v[212:215]
    v_mfma_f32_16x16x32_bf16 v[220:223], v[172:175], v[84:87], v[220:223]
    s_barrier
    v_mfma_f32_16x16x32_bf16 v[220:223], v[164:167], v[80:83], v[220:223]
    ds_read_b64_tr_b16 v[96:97], v241 offset:0
    ds_read_b64_tr_b16 v[98:99], v241 offset:1024
    v_mfma_f32_16x16x32_bf16 v[220:223], v[156:159], v[76:79], v[220:223]
    ds_read_b128 v[0:3], v240 offset:20480
    ds_read_b64_tr_b16 v[104:105], v241 offset:8192
    v_mfma_f32_16x16x32_bf16 v[220:223], v[148:151], v[72:75], v[220:223]
    ds_read_b64_tr_b16 v[106:107], v241 offset:9216
    ds_read_b128 v[4:7], v240 offset:20736
    v_mfma_f32_16x16x32_bf16 v[220:223], v[140:143], v[68:71], v[220:223]
    ds_read_b64_tr_b16 v[112:113], v241 offset:16384
    ds_read_b64_tr_b16 v[114:115], v241 offset:17408
    v_mfma_f32_16x16x32_bf16 v[228:231], v[140:143], v[72:75], v[228:231]
    ds_read_b128 v[8:11], v240 offset:20992
    ds_read_b64_tr_b16 v[120:121], v241 offset:24576
    v_mfma_f32_16x16x32_bf16 v[228:231], v[148:151], v[76:79], v[228:231]
    ds_read_b64_tr_b16 v[122:123], v241 offset:25600
    v_mfma_f32_16x16x32_bf16 v[228:231], v[156:159], v[80:83], v[228:231]
    ds_read_b128 v[12:15], v240 offset:21248
    v_mfma_f32_16x16x32_bf16 v[228:231], v[164:167], v[84:87], v[228:231]
    ds_read_b64_tr_b16 v[128:129], v241 offset:32768
    v_mfma_f32_16x16x32_bf16 v[228:231], v[172:175], v[88:91], v[228:231]
    ds_read_b64_tr_b16 v[130:131], v241 offset:33792
    v_mfma_f32_16x16x32_bf16 v[236:239], v[172:175], v[92:95], v[236:239]
    ds_read_b128 v[16:19], v240 offset:21520
    v_mfma_f32_16x16x32_bf16 v[236:239], v[164:167], v[88:91], v[236:239]
    ds_read_b128 v[20:23], v240 offset:21776
L_pad1:
    s_cbranch_vccnz L_padret0
    v_mfma_f32_16x16x32_bf16 v[236:239], v[156:159], v[84:87], v[236:239]
    ds_read_b128 v[24:27], v240 offset:22032
    v_mfma_f32_16x16x32_bf16 v[236:239], v[148:151], v[80:83], v[236:239]
    ds_read_b128 v[28:31], v240 offset:22288
    v_mfma_f32_16x16x32_bf16 v[236:239], v[140:143], v[76:79], v[236:239]
    ds_read_b128 v[32:35], v240 offset:22560
    s_waitcnt lgkmcnt(15)
    v_mfma_f32_16x16x32_bf16 v[176:179], v[96:99], v[0:3], v[176:179]
    ds_read_b128 v[36:39], v240 offset:22816
    s_waitcnt lgkmcnt(14)
    v_mfma_f32_16x16x32_bf16 v[176:179], v[104:107], v[4:7], v[176:179]
    ds_read_b128 v[40:43], v240 offset:23072
    s_waitcnt lgkmcnt(12)
    v_mfma_f32_16x16x32_bf16 v[176:179], v[112:115], v[8:11], v[176:179]
    ds_read_b128 v[44:47], v240 offset:23328
    s_waitcnt lgkmcnt(10)
    v_mfma_f32_16x16x32_bf16 v[176:179], v[120:123], v[12:15], v[176:179]
    ds_read_b64_tr_b16 v[100:101], v242 offset:0
    s_waitcnt lgkmcnt(8)
    v_mfma_f32_16x16x32_bf16 v[176:179], v[128:131], v[16:19], v[176:179]
    ds_read_b64_tr_b16 v[102:103], v242 offset:1024
    s_waitcnt lgkmcnt(8)
    v_mfma_f32_16x16x32_bf16 v[184:187], v[128:131], v[20:23], v[184:187]
    ds_read_b64_tr_b16 v[108:109], v242 offset:8192
    v_mfma_f32_16x16x32_bf16 v[184:187], v[120:123], v[16:19], v[184:187]
    ds_read_b64_tr_b16 v[110:111], v242 offset:9216
    v_mfma_f32_16x16x32_bf16 v[184:187], v[112:115], v[12:15], v[184:187]
    ds_read_b64_tr_b16 v[116:117], v242 offset:16384
    v_mfma_f32_16x16x32_bf16 v[184:187], v[104:107], v[8:11], v[184:187]
    ds_read_b64_tr_b16 v[118:119], v242 offset:17408
    v_mfma_f32_16x16x32_bf16 v[184:187], v[96:99], v[4:7], v[184:187]
    ds_read_b64_tr_b16 v[124:125], v242 offset:24576
    v_mfma_f32_16x16x32_bf16 v[192:195], v[96:99], v[8:11], v[192:195]
    ds_read_b64_tr_b16 v[126:127], v242 offset:25600
    v_mfma_f32_16x16x32_bf16 v[192:195], v[104:107], v[12:15], v[192:195]
    ds_read_b64_tr_b16 v[132:133], v242 offset:32768
    v_mfma_f32_16x16x32_bf16 v[192:195], v[112:115], v[16:19], v[192:195]
    ds_read_b64_tr_b16 v[134:135], v242 offset:33792
    v_mfma_f32_16x16x32_bf16 v[192:195], v[120:123], v[20:23], v[192:195]
    v_add_u32 v241, s43, v241
    ds_read_b128 v[48:51], v240 offset:20544
    s_waitcnt lgkmcnt(15)
    v_mfma_f32_16x16x32_bf16 v[192:195], v[128:131], v[24:27], v[192:195]
    v_add_u32 v242, s43, v242
    ds_read_b128 v[52:55], v240 offset:20800
    v_mfma_f32_16x16x32_bf16 v[200:203], v[128:131], v[28:31], v[200:203]
    ds_read_b128 v[56:59], v240 offset:21056
    v_mfma_f32_16x16x32_bf16 v[200:203], v[120:123], v[24:27], v[200:203]
    ds_read_b128 v[60:63], v240 offset:21312
    v_mfma_f32_16x16x32_bf16 v[200:203], v[112:115], v[20:23], v[200:203]
    ds_read_b128 v[64:67], v240 offset:21584
    v_mfma_f32_16x16x32_bf16 v[200:203], v[104:107], v[16:19], v[200:203]
    ds_read_b128 v[68:71], v240 offset:21840
    v_mfma_f32_16x16x32_bf16 v[200:203], v[96:99], v[12:15], v[200:203]
    ds_read_b128 v[72:75], v240 offset:22096
    v_mfma_f32_16x16x32_bf16 v[208:211], v[96:99], v[16:19], v[208:211]
    ds_read_b128 v[76:79], v240 offset:22352
    v_mfma_f32_16x16x32_bf16 v[208:211], v[104:107], v[20:23], v[208:211]
    ds_read_b128 v[80:83], v240 offset:22624
    v_mfma_f32_16x16x32_bf16 v[208:211], v[112:115], v[24:27], v[208:211]
    ds_read_b128 v[84:87], v240 offset:22880
    v_mfma_f32_16x16x32_bf16 v[208:211], v[120:123], v[28:31], v[208:211]
    ds_read_b128 v[88:91], v240 offset:23136
    s_waitcnt lgkmcnt(15)
    v_mfma_f32_16x16x32_bf16 v[208:211], v[128:131], v[32:35], v[208:211]
    ds_read_b128 v[92:95], v240 offset:23392
    v_mfma_f32_16x16x32_bf16 v[216:219], v[128:131], v[36:39], v[216:219]
    v_mfma_f32_16x16x32_bf16 v[216:219], v[120:123], v[32:35], v[216:219]
    v_mfma_f32_16x16x32_bf16 v[216:219], v[112:115], v[28:31], v[216:219]
    v_mfma_f32_16x16x32_bf16 v[216:219], v[104:107], v[24:27], v[216:219]
    v_mfma_f32_16x16x32_bf16 v[216:219], v[96:99], v[20:23], v[216:219]
    v_mfma_f32_16x16x32_bf16 v[224:227], v[96:99], v[24:27], v[224:227]
    v_mfma_f32_16x16x32_bf16 v[224:227], v[104:107], v[28:31], v[224:227]
    v_mfma_f32_16x16x32_bf16 v[224:227], v[112:115], v[32:35], v[224:227]
    v_mfma_f32_16x16x32_bf16 v[224:227], v[120:123], v[36:39], v[224:227]
    v_mfma_f32_16x16x32_bf16 v[224:227], v[128:131], v[40:43], v[224:227]
    v_mfma_f32_16x16x32_bf16 v[232:235], v[128:131], v[44:47], v[232:235]
    v_mfma_f32_16x16x32_bf16 v[232:235], v[120:123], v[40:43], v[232:235]
    v_mfma_f32_16x16x32_bf16 v[232:235], v[112:115], v[36:39], v[232:235]
    v_mfma_f32_16x16x32_bf16 v[232:235], v[104:107], v[32:35], v[232:235]
    v_mfma_f32_16x16x32_bf16 v[232:235], v[96:99], v[28:31], v[232:235]
    v_mfma_f32_16x16x32_bf16 v[180:183], v[100:103], v[0:3], v[180:183]
    v_mfma_f32_16x16x32_bf16 v[180:183], v[108:111], v[4:7], v[180:183]
    v_mfma_f32_16x16x32_bf16 v[180:183], v[116:119], v[8:11], v[180:183]
    s_waitcnt lgkmcnt(14)
    v_mfma_f32_16x16x32_bf16 v[180:183], v[124:127], v[12:15], v[180:183]
    s_waitcnt lgkmcnt(12)
    v_mfma_f32_16x16x32_bf16 v[180:183], v[132:135], v[16:19], v[180:183]
    v_mfma_f32_16x16x32_bf16 v[188:191], v[132:135], v[20:23], v[188:191]
    v_mfma_f32_16x16x32_bf16 v[188:191], v[124:127], v[16:19], v[188:191]
    v_mfma_f32_16x16x32_bf16 v[188:191], v[116:119], v[12:15], v[188:191]
    v_mfma_f32_16x16x32_bf16 v[188:191], v[108:111], v[8:11], v[188:191]
    v_mfma_f32_16x16x32_bf16 v[188:191], v[100:103], v[4:7], v[188:191]
    v_mfma_f32_16x16x32_bf16 v[196:199], v[100:103], v[8:11], v[196:199]
    v_mfma_f32_16x16x32_bf16 v[196:199], v[108:111], v[12:15], v[196:199]
    v_mfma_f32_16x16x32_bf16 v[196:199], v[116:119], v[16:19], v[196:199]
    v_mfma_f32_16x16x32_bf16 v[196:199], v[124:127], v[20:23], v[196:199]
    v_mfma_f32_16x16x32_bf16 v[196:199], v[132:135], v[24:27], v[196:199]
    v_mfma_f32_16x16x32_bf16 v[204:207], v[132:135], v[28:31], v[204:207]
    s_barrier
    v_mfma_f32_16x16x32_bf16 v[204:207], v[124:127], v[24:27], v[204:207]
    ds_read_b64_tr_b16 v[136:137], v241 offset:0
    v_mfma_f32_16x16x32_bf16 v[204:207], v[116:119], v[20:23], v[204:207]
    ds_read_b64_tr_b16 v[138:139], v241 offset:1024
    v_mfma_f32_16x16x32_bf16 v[204:207], v[108:111], v[16:19], v[204:207]
    ds_read_b64_tr_b16 v[144:145], v241 offset:8192
    v_mfma_f32_16x16x32_bf16 v[204:207], v[100:103], v[12:15], v[204:207]
    ds_read_b64_tr_b16 v[146:147], v241 offset:9216
    v_mfma_f32_16x16x32_bf16 v[212:215], v[100:103], v[16:19], v[212:215]
    ds_read_b64_tr_b16 v[152:153], v241 offset:16384
    v_mfma_f32_16x16x32_bf16 v[212:215], v[108:111], v[20:23], v[212:215]
    ds_read_b64_tr_b16 v[154:155], v241 offset:17408
    v_mfma_f32_16x16x32_bf16 v[212:215], v[116:119], v[24:27], v[212:215]
    ds_read_b64_tr_b16 v[160:161], v241 offset:24576
    v_mfma_f32_16x16x32_bf16 v[212:215], v[124:127], v[28:31], v[212:215]
    ds_read_b64_tr_b16 v[162:163], v241 offset:25600
    v_mfma_f32_16x16x32_bf16 v[212:215], v[132:135], v[32:35], v[212:215]
    ds_read_b64_tr_b16 v[168:169], v241 offset:32768
    v_mfma_f32_16x16x32_bf16 v[220:223], v[132:135], v[36:39], v[220:223]
    ds_read_b64_tr_b16 v[170:171], v241 offset:33792
    v_mfma_f32_16x16x32_bf16 v[220:223], v[124:127], v[32:35], v[220:223]
    ds_read_b64_tr_b16 v[140:141], v242 offset:0
    v_mfma_f32_16x16x32_bf16 v[220:223], v[116:119], v[28:31], v[220:223]
    ds_read_b64_tr_b16 v[142:143], v242 offset:1024
    v_mfma_f32_16x16x32_bf16 v[220:223], v[108:111], v[24:27], v[220:223]
    ds_read_b64_tr_b16 v[148:149], v242 offset:8192
    v_mfma_f32_16x16x32_bf16 v[220:223], v[100:103], v[20:23], v[220:223]
    ds_read_b64_tr_b16 v[150:151], v242 offset:9216
    v_mfma_f32_16x16x32_bf16 v[228:231], v[100:103], v[24:27], v[228:231]
    ds_read_b64_tr_b16 v[156:157], v242 offset:16384
    v_mfma_f32_16x16x32_bf16 v[228:231], v[108:111], v[28:31], v[228:231]
    ds_read_b64_tr_b16 v[158:159], v242 offset:17408
    v_mfma_f32_16x16x32_bf16 v[228:231], v[116:119], v[32:35], v[228:231]
    ds_read_b64_tr_b16 v[164:165], v242 offset:24576
    v_mfma_f32_16x16x32_bf16 v[228:231], v[124:127], v[36:39], v[228:231]
    ds_read_b64_tr_b16 v[166:167], v242 offset:25600
    v_mfma_f32_16x16x32_bf16 v[228:231], v[132:135], v[40:43], v[228:231]
    ds_read_b64_tr_b16 v[172:173], v242 offset:32768
    v_mfma_f32_16x16x32_bf16 v[236:239], v[132:135], v[44:47], v[236:239]
    ds_read_b64_tr_b16 v[174:175], v242 offset:33792
    v_mfma_f32_16x16x32_bf16 v[236:239], v[124:127], v[40:43], v[236:239]
    v_add_u32 v241, s42, v241
    v_mfma_f32_16x16x32_bf16 v[236:239], v[116:119], v[36:39], v[236:239]
    v_add_u32 v242, s42, v242
    v_mfma_f32_16x16x32_bf16 v[236:239], v[108:111], v[32:35], v[236:239]
    v_mfma_f32_16x16x32_bf16 v[236:239], v[100:103], v[28:31], v[236:239]
    s_waitcnt lgkmcnt(15)
    v_mfma_f32_16x16x32_bf16 v[176:179], v[136:139], v[48:51], v[176:179]
    v_mfma_f32_16x16x32_bf16 v[176:179], v[144:147], v[52:55], v[176:179]
    s_waitcnt lgkmcnt(14)
    v_mfma_f32_16x16x32_bf16 v[176:179], v[152:155], v[56:59], v[176:179]
    s_waitcnt lgkmcnt(12)
    v_mfma_f32_16x16x32_bf16 v[176:179], v[160:163], v[60:63], v[176:179]
    s_waitcnt lgkmcnt(10)
    v_mfma_f32_16x16x32_bf16 v[176:179], v[168:171], v[64:67], v[176:179]
    v_mfma_f32_16x16x32_bf16 v[184:187], v[168:171], v[68:71], v[184:187]
    v_mfma_f32_16x16x32_bf16 v[184:187], v[160:163], v[64:67], v[184:187]
    v_mfma_f32_16x16x32_bf16 v[184:187], v[152:155], v[60:63], v[184:187]
    v_mfma_f32_16x16x32_bf16 v[184:187], v[144:147], v[56:59], v[184:187]
    v_mfma_f32_16x16x32_bf16 v[184:187], v[136:139], v[52:55], v[184:187]
    v_mfma_f32_16x16x32_bf16 v[192:195], v[136:139], v[56:59], v[192:195]
    v_mfma_f32_16x16x32_bf16 v[192:195], v[144:147], v[60:63], v[192:195]
    v_mfma_f32_16x16x32_bf16 v[192:195], v[152:155], v[64:67], v[192:195]
    v_mfma_f32_16x16x32_bf16 v[192:195], v[160:163], v[68:71], v[192:195]
    v_mfma_f32_16x16x32_bf16 v[192:195], v[168:171], v[72:75], v[192:195]
    v_mfma_f32_16x16x32_bf16 v[200:203], v[168:171], v[76:79], v[200:203]
    v_mfma_f32_16x16x32_bf16 v[200:203], v[160:163], v[72:75], v[200:203]
    v_mfma_f32_16x16x32_bf16 v[200:203], v[152:155], v[68:71], v[200:203]
    v_mfma_f32_16x16x32_bf16 v[200:203], v[144:147], v[64:67], v[200:203]
    v_mfma_f32_16x16x32_bf16 v[200:203], v[136:139], v[60:63], v[200:203]
    v_mfma_f32_16x16x32_bf16 v[208:211], v[136:139], v[64:67], v[208:211]
    v_mfma_f32_16x16x32_bf16 v[208:211], v[144:147], v[68:71], v[208:211]
    v_mfma_f32_16x16x32_bf16 v[208:211], v[152:155], v[72:75], v[208:211]
    v_mfma_f32_16x16x32_bf16 v[208:211], v[160:163], v[76:79], v[208:211]
    v_mfma_f32_16x16x32_bf16 v[208:211], v[168:171], v[80:83], v[208:211]
    v_mfma_f32_16x16x32_bf16 v[216:219], v[168:171], v[84:87], v[216:219]
    v_mfma_f32_16x16x32_bf16 v[216:219], v[160:163], v[80:83], v[216:219]
    v_mfma_f32_16x16x32_bf16 v[216:219], v[152:155], v[76:79], v[216:219]
    v_mfma_f32_16x16x32_bf16 v[216:219], v[144:147], v[72:75], v[216:219]
    v_mfma_f32_16x16x32_bf16 v[216:219], v[136:139], v[68:71], v[216:219]
    v_mfma_f32_16x16x32_bf16 v[224:227], v[136:139], v[72:75], v[224:227]
    v_mfma_f32_16x16x32_bf16 v[224:227], v[144:147], v[76:79], v[224:227]
    v_mfma_f32_16x16x32_bf16 v[224:227], v[152:155], v[80:83], v[224:227]
    v_mfma_f32_16x16x32_bf16 v[224:227], v[160:163], v[84:87], v[224:227]
    v_mfma_f32_16x16x32_bf16 v[224:227], v[168:171], v[88:91], v[224:227]
    v_mfma_f32_16x16x32_bf16 v[232:235], v[168:171], v[92:95], v[232:235]
    v_mfma_f32_16x16x32_bf16 v[232:235], v[160:163], v[88:91], v[232:235]
    v_mfma_f32_16x16x32_bf16 v[232:235], v[152:155], v[84:87], v[232:235]
    v_mfma_f32_16x16x32_bf16 v[232:235], v[144:147], v[80:83], v[232:235]
    v_mfma_f32_16x16x32_bf16 v[232:235], v[136:139], v[76:79], v[232:235]
    s_waitcnt lgkmcnt(8)
    v_mfma_f32_16x16x32_bf16 v[180:183], v[140:143], v[48:51], v[180:183]
    s_waitcnt lgkmcnt(6)
    v_mfma_f32_16x16x32_bf16 v[180:183], v[148:151], v[52:55], v[180:183]
    s_waitcnt lgkmcnt(0)
    s_barrier
    v_mfma_f32_16x16x32_bf16 v[180:183], v[156:159], v[56:59], v[180:183]
    ds_read_b64_tr_b16 v[96:97], v241 offset:0
    v_mfma_f32_16x16x32_bf16 v[180:183], v[164:167], v[60:63], v[180:183]
    ds_read_b64_tr_b16 v[98:99], v241 offset:1024
    v_mfma_f32_16x16x32_bf16 v[180:183], v[172:175], v[64:67], v[180:183]
    ds_read_b128 v[0:3], v240 offset:0
    v_mfma_f32_16x16x32_bf16 v[188:191], v[172:175], v[68:71], v[188:191]
    ds_read_b64_tr_b16 v[104:105], v241 offset:8192
    v_mfma_f32_16x16x32_bf16 v[188:191], v[164:167], v[64:67], v[188:191]
    ds_read_b64_tr_b16 v[106:107], v241 offset:9216
    v_mfma_f32_16x16x32_bf16 v[188:191], v[156:159], v[60:63], v[188:191]
    ds_read_b128 v[4:7], v240 offset:256
    v_mfma_f32_16x16x32_bf16 v[188:191], v[148:151], v[56:59], v[188:191]
    ds_read_b64_tr_b16 v[112:113], v241 offset:16384
    v_mfma_f32_16x16x32_bf16 v[188:191], v[140:143], v[52:55], v[188:191]
    ds_read_b64_tr_b16 v[114:115], v241 offset:17408
    v_mfma_f32_16x16x32_bf16 v[196:199], v[140:143], v[56:59], v[196:199]
    ds_read_b128 v[8:11], v240 offset:512
    v_mfma_f32_16x16x32_bf16 v[196:199], v[148:151], v[60:63], v[196:199]
    ds_read_b64_tr_b16 v[120:121], v241 offset:24576
    v_mfma_f32_16x16x32_bf16 v[196:199], v[156:159], v[64:67], v[196:199]
    ds_read_b64_tr_b16 v[122:123], v241 offset:25600
    v_mfma_f32_16x16x32_bf16 v[196:199], v[164:167], v[68:71], v[196:199]
    ds_read_b128 v[12:15], v240 offset:768
    v_mfma_f32_16x16x32_bf16 v[196:199], v[172:175], v[72:75], v[196:199]
    ds_read_b64_tr_b16 v[128:129], v241 offset:32768
    v_mfma_f32_16x16x32_bf16 v[204:207], v[172:175], v[76:79], v[204:207]
    ds_read_b64_tr_b16 v[130:131], v241 offset:33792
    v_mfma_f32_16x16x32_bf16 v[204:207], v[164:167], v[72:75], v[204:207]
    ds_read_b128 v[16:19], v240 offset:1040
    v_mfma_f32_16x16x32_bf16 v[204:207], v[156:159], v[68:71], v[204:207]
    ds_read_b128 v[20:23], v240 offset:1296
    v_mfma_f32_16x16x32_bf16 v[204:207], v[148:151], v[64:67], v[204:207]
    ds_read_b128 v[24:27], v240 offset:1552
    v_mfma_f32_16x16x32_bf16 v[204:207], v[140:143], v[60:63], v[204:207]
    ds_read_b128 v[28:31], v240 offset:1808
    v_mfma_f32_16x16x32_bf16 v[212:215], v[140:143], v[64:67], v[212:215]
    ds_read_b128 v[32:35], v240 offset:2080
    v_mfma_f32_16x16x32_bf16 v[212:215], v[148:151], v[68:71], v[212:215]
    ds_read_b128 v[36:39], v240 offset:2336
    v_mfma_f32_16x16x32_bf16 v[212:215], v[156:159], v[72:75], v[212:215]
    ds_read_b128 v[40:43], v240 offset:2592
    v_mfma_f32_16x16x32_bf16 v[212:215], v[164:167], v[76:79], v[212:215]
    ds_read_b128 v[44:47], v240 offset:2848
    v_mfma_f32_16x16x32_bf16 v[212:215], v[172:175], v[80:83], v[212:215]
    ds_read_b64_tr_b16 v[100:101], v242 offset:0
    v_mfma_f32_16x16x32_bf16 v[220:223], v[172:175], v[84:87], v[220:223]
    ds_read_b64_tr_b16 v[102:103], v242 offset:1024
    v_mfma_f32_16x16x32_bf16 v[220:223], v[164:167], v[80:83], v[220:223]
    ds_read_b64_tr_b16 v[108:109], v242 offset:8192
    v_mfma_f32_16x16x32_bf16 v[220:223], v[156:159], v[76:79], v[220:223]
    ds_read_b64_tr_b16 v[110:111], v242 offset:9216
    v_mfma_f32_16x16x32_bf16 v[220:223], v[148:151], v[72:75], v[220:223]
    ds_read_b64_tr_b16 v[116:117], v242 offset:16384
    v_mfma_f32_16x16x32_bf16 v[220:223], v[140:143], v[68:71], v[220:223]
    ds_read_b64_tr_b16 v[118:119], v242 offset:17408
    v_mfma_f32_16x16x32_bf16 v[228:231], v[140:143], v[72:75], v[228:231]
    ds_read_b64_tr_b16 v[124:125], v242 offset:24576
    v_mfma_f32_16x16x32_bf16 v[228:231], v[148:151], v[76:79], v[228:231]
    ds_read_b64_tr_b16 v[126:127], v242 offset:25600
    v_mfma_f32_16x16x32_bf16 v[228:231], v[156:159], v[80:83], v[228:231]
    ds_read_b64_tr_b16 v[132:133], v242 offset:32768
    v_mfma_f32_16x16x32_bf16 v[228:231], v[164:167], v[84:87], v[228:231]
    ds_read_b64_tr_b16 v[134:135], v242 offset:33792
    v_mfma_f32_16x16x32_bf16 v[228:231], v[172:175], v[88:91], v[228:231]
    v_add_u32 v241, s42, v241
    ds_read_b128 v[48:51], v240 offset:64
    v_mfma_f32_16x16x32_bf16 v[236:239], v[172:175], v[92:95], v[236:239]
    v_add_u32 v242, s42, v242
    ds_read_b128 v[52:55], v240 offset:320
    v_mfma_f32_16x16x32_bf16 v[236:239], v[164:167], v[88:91], v[236:239]
    ds_read_b128 v[56:59], v240 offset:576
    v_mfma_f32_16x16x32_bf16 v[236:239], v[156:159], v[84:87], v[236:239]
    ds_read_b128 v[60:63], v240 offset:832
    v_mfma_f32_16x16x32_bf16 v[236:239], v[148:151], v[80:83], v[236:239]
    ds_read_b128 v[64:67], v240 offset:1104
    v_mfma_f32_16x16x32_bf16 v[236:239], v[140:143], v[76:79], v[236:239]
    ds_read_b128 v[68:71], v240 offset:1360
    s_waitcnt lgkmcnt(15)
    v_mfma_f32_16x16x32_bf16 v[176:179], v[96:99], v[0:3], v[176:179]
    ds_read_b128 v[72:75], v240 offset:1616
    v_mfma_f32_16x16x32_bf16 v[176:179], v[104:107], v[4:7], v[176:179]
    ds_read_b128 v[76:79], v240 offset:1872
    v_mfma_f32_16x16x32_bf16 v[176:179], v[112:115], v[8:11], v[176:179]
    ds_read_b128 v[80:83], v240 offset:2144
    v_mfma_f32_16x16x32_bf16 v[176:179], v[120:123], v[12:15], v[176:179]
    ds_read_b128 v[84:87], v240 offset:2400
    v_mfma_f32_16x16x32_bf16 v[176:179], v[128:131], v[16:19], v[176:179]
    v_mfma_f32_16x16x32_bf16 v[184:187], v[128:131], v[20:23], v[184:187]
    v_mfma_f32_16x16x32_bf16 v[184:187], v[120:123], v[16:19], v[184:187]
    v_mfma_f32_16x16x32_bf16 v[184:187], v[112:115], v[12:15], v[184:187]
    v_mfma_f32_16x16x32_bf16 v[184:187], v[104:107], v[8:11], v[184:187]
    v_mfma_f32_16x16x32_bf16 v[184:187], v[96:99], v[4:7], v[184:187]
    v_mfma_f32_16x16x32_bf16 v[192:195], v[96:99], v[8:11], v[192:195]
    v_mfma_f32_16x16x32_bf16 v[192:195], v[104:107], v[12:15], v[192:195]
    v_mfma_f32_16x16x32_bf16 v[192:195], v[112:115], v[16:19], v[192:195]
    v_mfma_f32_16x16x32_bf16 v[192:195], v[120:123], v[20:23], v[192:195]
    v_mfma_f32_16x16x32_bf16 v[192:195], v[128:131], v[24:27], v[192:195]
    v_mfma_f32_16x16x32_bf16 v[200:203], v[128:131], v[28:31], v[200:203]
    v_mfma_f32_16x16x32_bf16 v[200:203], v[120:123], v[24:27], v[200:203]
    v_mfma_f32_16x16x32_bf16 v[200:203], v[112:115], v[20:23], v[200:203]
    v_mfma_f32_16x16x32_bf16 v[200:203], v[104:107], v[16:19], v[200:203]
    v_mfma_f32_16x16x32_bf16 v[200:203], v[96:99], v[12:15], v[200:203]
    v_mfma_f32_16x16x32_bf16 v[208:211], v[96:99], v[16:19], v[208:211]
    v_mfma_f32_16x16x32_bf16 v[208:211], v[104:107], v[20:23], v[208:211]
    v_mfma_f32_16x16x32_bf16 v[208:211], v[112:115], v[24:27], v[208:211]
    v_mfma_f32_16x16x32_bf16 v[208:211], v[120:123], v[28:31], v[208:211]
    v_mfma_f32_16x16x32_bf16 v[208:211], v[128:131], v[32:35], v[208:211]
    v_mfma_f32_16x16x32_bf16 v[216:219], v[128:131], v[36:39], v[216:219]
    v_mfma_f32_16x16x32_bf16 v[216:219], v[120:123], v[32:35], v[216:219]
    v_mfma_f32_16x16x32_bf16 v[216:219], v[112:115], v[28:31], v[216:219]
    v_mfma_f32_16x16x32_bf16 v[216:219], v[104:107], v[24:27], v[216:219]
    v_mfma_f32_16x16x32_bf16 v[216:219], v[96:99], v[20:23], v[216:219]
    v_mfma_f32_16x16x32_bf16 v[224:227], v[96:99], v[24:27], v[224:227]
    v_mfma_f32_16x16x32_bf16 v[224:227], v[104:107], v[28:31], v[224:227]
    v_mfma_f32_16x16x32_bf16 v[224:227], v[112:115], v[32:35], v[224:227]
    v_mfma_f32_16x16x32_bf16 v[224:227], v[120:123], v[36:39], v[224:227]
    v_mfma_f32_16x16x32_bf16 v[224:227], v[128:131], v[40:43], v[224:227]
    v_mfma_f32_16x16x32_bf16 v[232:235], v[128:131], v[44:47], v[232:235]
    v_mfma_f32_16x16x32_bf16 v[232:235], v[120:123], v[40:43], v[232:235]
    v_mfma_f32_16x16x32_bf16 v[232:235], v[112:115], v[36:39], v[232:235]
    s_waitcnt lgkmcnt(10)
    s_barrier
    v_mfma_f32_16x16x32_bf16 v[232:235], v[104:107], v[32:35], v[232:235]
    ds_read_b64_tr_b16 v[136:137], v241 offset:0
    v_mfma_f32_16x16x32_bf16 v[232:235], v[96:99], v[28:31], v[232:235]
    ds_read_b64_tr_b16 v[138:139], v241 offset:1024
    v_mfma_f32_16x16x32_bf16 v[180:183], v[100:103], v[0:3], v[180:183]
    ds_read_b64_tr_b16 v[144:145], v241 offset:8192
    v_mfma_f32_16x16x32_bf16 v[180:183], v[108:111], v[4:7], v[180:183]
    ds_read_b64_tr_b16 v[146:147], v241 offset:9216
    v_mfma_f32_16x16x32_bf16 v[180:183], v[116:119], v[8:11], v[180:183]
    ds_read_b64_tr_b16 v[152:153], v241 offset:16384
    v_mfma_f32_16x16x32_bf16 v[180:183], v[124:127], v[12:15], v[180:183]
    ds_read_b64_tr_b16 v[154:155], v241 offset:17408
    v_mfma_f32_16x16x32_bf16 v[180:183], v[132:135], v[16:19], v[180:183]
    ds_read_b64_tr_b16 v[160:161], v241 offset:24576
    v_mfma_f32_16x16x32_bf16 v[188:191], v[132:135], v[20:23], v[188:191]
    ds_read_b64_tr_b16 v[162:163], v241 offset:25600
    v_mfma_f32_16x16x32_bf16 v[188:191], v[124:127], v[16:19], v[188:191]
    ds_read_b64_tr_b16 v[168:169], v241 offset:32768
    v_mfma_f32_16x16x32_bf16 v[188:191], v[116:119], v[12:15], v[188:191]
    ds_read_b64_tr_b16 v[170:171], v241 offset:33792
    v_mfma_f32_16x16x32_bf16 v[188:191], v[108:111], v[8:11], v[188:191]
    ds_read_b64_tr_b16 v[140:141], v242 offset:0
    v_mfma_f32_16x16x32_bf16 v[188:191], v[100:103], v[4:7], v[188:191]
    ds_read_b64_tr_b16 v[142:143], v242 offset:1024
    v_mfma_f32_16x16x32_bf16 v[196:199], v[100:103], v[8:11], v[196:199]
    ds_read_b64_tr_b16 v[148:149], v242 offset:8192
    v_mfma_f32_16x16x32_bf16 v[196:199], v[108:111], v[12:15], v[196:199]
    ds_read_b64_tr_b16 v[150:151], v242 offset:9216
    v_mfma_f32_16x16x32_bf16 v[196:199], v[116:119], v[16:19], v[196:199]
    ds_read_b64_tr_b16 v[156:157], v242 offset:16384
    v_mfma_f32_16x16x32_bf16 v[196:199], v[124:127], v[20:23], v[196:199]
    ds_read_b64_tr_b16 v[158:159], v242 offset:17408
    v_mfma_f32_16x16x32_bf16 v[196:199], v[132:135], v[24:27], v[196:199]
    ds_read_b64_tr_b16 v[164:165], v242 offset:24576
    v_mfma_f32_16x16x32_bf16 v[204:207], v[132:135], v[28:31], v[204:207]
    ds_read_b64_tr_b16 v[166:167], v242 offset:25600
    v_mfma_f32_16x16x32_bf16 v[204:207], v[124:127], v[24:27], v[204:207]
    ds_read_b64_tr_b16 v[172:173], v242 offset:32768
    v_mfma_f32_16x16x32_bf16 v[204:207], v[116:119], v[20:23], v[204:207]
    ds_read_b64_tr_b16 v[174:175], v242 offset:33792
    v_mfma_f32_16x16x32_bf16 v[204:207], v[108:111], v[16:19], v[204:207]
    v_mfma_f32_16x16x32_bf16 v[204:207], v[100:103], v[12:15], v[204:207]
    v_mfma_f32_16x16x32_bf16 v[212:215], v[100:103], v[16:19], v[212:215]
    v_mfma_f32_16x16x32_bf16 v[212:215], v[108:111], v[20:23], v[212:215]
    v_mfma_f32_16x16x32_bf16 v[212:215], v[116:119], v[24:27], v[212:215]
    v_mfma_f32_16x16x32_bf16 v[212:215], v[124:127], v[28:31], v[212:215]
    v_mfma_f32_16x16x32_bf16 v[212:215], v[132:135], v[32:35], v[212:215]
    v_mfma_f32_16x16x32_bf16 v[220:223], v[132:135], v[36:39], v[220:223]
    v_mfma_f32_16x16x32_bf16 v[220:223], v[124:127], v[32:35], v[220:223]
    v_mfma_f32_16x16x32_bf16 v[220:223], v[116:119], v[28:31], v[220:223]
    v_mfma_f32_16x16x32_bf16 v[220:223], v[108:111], v[24:27], v[220:223]
    v_mfma_f32_16x16x32_bf16 v[220:223], v[100:103], v[20:23], v[220:223]
    v_mfma_f32_16x16x32_bf16 v[228:231], v[100:103], v[24:27], v[228:231]
    v_mfma_f32_16x16x32_bf16 v[228:231], v[108:111], v[28:31], v[228:231]
    v_mfma_f32_16x16x32_bf16 v[228:231], v[116:119], v[32:35], v[228:231]
    v_mfma_f32_16x16x32_bf16 v[228:231], v[124:127], v[36:39], v[228:231]
    v_mfma_f32_16x16x32_bf16 v[228:231], v[132:135], v[40:43], v[228:231]
    v_mfma_f32_16x16x32_bf16 v[236:239], v[132:135], v[44:47], v[236:239]
    v_mfma_f32_16x16x32_bf16 v[236:239], v[124:127], v[40:43], v[236:239]
    v_mfma_f32_16x16x32_bf16 v[236:239], v[116:119], v[36:39], v[236:239]
    v_mfma_f32_16x16x32_bf16 v[236:239], v[108:111], v[32:35], v[236:239]
    v_mfma_f32_16x16x32_bf16 v[236:239], v[100:103], v[28:31], v[236:239]
L_tail:
    s_waitcnt lgkmcnt(14)
    v_mfma_f32_16x16x32_bf16 v[176:179], v[136:139], v[48:51], v[176:179]
    v_add_u32 v241, s43, v241
    v_mfma_f32_16x16x32_bf16 v[176:179], v[144:147], v[52:55], v[176:179]
    v_add_u32 v242, s43, v242
    v_mfma_f32_16x16x32_bf16 v[176:179], v[152:155], v[56:59], v[176:179]
    s_waitcnt lgkmcnt(10)
    v_mfma_f32_16x16x32_bf16 v[176:179], v[160:163], v[60:63], v[176:179]
    v_mfma_f32_16x16x32_bf16 v[176:179], v[168:171], v[64:67], v[176:179]
    v_mfma_f32_16x16x32_bf16 v[184:187], v[168:171], v[68:71], v[184:187]
    v_mfma_f32_16x16x32_bf16 v[184:187], v[160:163], v[64:67], v[184:187]
    v_mfma_f32_16x16x32_bf16 v[184:187], v[152:155], v[60:63], v[184:187]
    v_mfma_f32_16x16x32_bf16 v[184:187], v[144:147], v[56:59], v[184:187]
    v_mfma_f32_16x16x32_bf16 v[184:187], v[136:139], v[52:55], v[184:187]
    v_mfma_f32_16x16x32_bf16 v[192:195], v[136:139], v[56:59], v[192:195]
    v_mfma_f32_16x16x32_bf16 v[192:195], v[144:147], v[60:63], v[192:195]
    v_mfma_f32_16x16x32_bf16 v[192:195], v[152:155], v[64:67], v[192:195]
    v_mfma_f32_16x16x32_bf16 v[192:195], v[160:163], v[68:71], v[192:195]
    v_mfma_f32_16x16x32_bf16 v[192:195], v[168:171], v[72:75], v[192:195]
    v_mfma_f32_16x16x32_bf16 v[200:203], v[168:171], v[76:79], v[200:203]
    v_mfma_f32_16x16x32_bf16 v[200:203], v[160:163], v[72:75], v[200:203]
    v_mfma_f32_16x16x32_bf16 v[200:203], v[152:155], v[68:71], v[200:203]
    s_waitcnt lgkmcnt(0)
    s_barrier
    v_mfma_f32_16x16x32_bf16 v[200:203], v[144:147], v[64:67], v[200:203]
    ds_read_b64_tr_b16 v[96:97], v241 offset:0
    ds_read_b64_tr_b16 v[98:99], v241 offset:1024
    v_mfma_f32_16x16x32_bf16 v[200:203], v[136:139], v[60:63], v[200:203]
    ds_read_b128 v[40:43], v240 offset:20480
    ds_read_b64_tr_b16 v[104:105], v241 offset:8192
    v_mfma_f32_16x16x32_bf16 v[204:207], v[140:143], v[60:63], v[204:207]
    ds_read_b64_tr_b16 v[106:107], v241 offset:9216
    ds_read_b128 v[44:47], v240 offset:20736
    v_mfma_f32_16x16x32_bf16 v[204:207], v[148:151], v[64:67], v[204:207]
    ds_read_b64_tr_b16 v[112:113], v241 offset:16384
    ds_read_b64_tr_b16 v[114:115], v241 offset:17408
    v_mfma_f32_16x16x32_bf16 v[204:207], v[156:159], v[68:71], v[204:207]
    ds_read_b128 v[248:251], v240 offset:20992
    ds_read_b64_tr_b16 v[120:121], v241 offset:24576
    v_mfma_f32_16x16x32_bf16 v[204:207], v[164:167], v[72:75], v[204:207]
    ds_read_b64_tr_b16 v[122:123], v241 offset:25600
    ds_read_b128 v[252:255], v240 offset:21248
    v_mfma_f32_16x16x32_bf16 v[204:207], v[172:175], v[76:79], v[204:207]
    ds_read_b64_tr_b16 v[128:129], v241 offset:32768
    ds_read_b64_tr_b16 v[130:131], v241 offset:33792
    v_mfma_f32_16x16x32_bf16 v[196:199], v[172:175], v[72:75], v[196:199]
    ds_read_b128 v[88:91], v240 offset:21520
    ds_read_b128 v[92:95], v240 offset:21776
    v_mfma_f32_16x16x32_bf16 v[196:199], v[164:167], v[68:71], v[196:199]
    ds_read_b64_tr_b16 v[100:101], v242 offset:0
    ds_read_b64_tr_b16 v[102:103], v242 offset:1024
    v_mfma_f32_16x16x32_bf16 v[196:199], v[156:159], v[64:67], v[196:199]
    ds_read_b64_tr_b16 v[108:109], v242 offset:8192
    ds_read_b64_tr_b16 v[110:111], v242 offset:9216
    v_mfma_f32_16x16x32_bf16 v[196:199], v[148:151], v[60:63], v[196:199]
    ds_read_b64_tr_b16 v[116:117], v242 offset:16384
    ds_read_b64_tr_b16 v[118:119], v242 offset:17408
    v_mfma_f32_16x16x32_bf16 v[196:199], v[140:143], v[56:59], v[196:199]
    ds_read_b64_tr_b16 v[124:125], v242 offset:24576
    ds_read_b64_tr_b16 v[126:127], v242 offset:25600
    v_mfma_f32_16x16x32_bf16 v[188:191], v[140:143], v[52:55], v[188:191]
    ds_read_b64_tr_b16 v[132:133], v242 offset:32768
    ds_read_b64_tr_b16 v[134:135], v242 offset:33792
    v_mfma_f32_16x16x32_bf16 v[188:191], v[148:151], v[56:59], v[188:191]
    v_add_u32 v241, s42, v241
    v_mfma_f32_16x16x32_bf16 v[188:191], v[156:159], v[60:63], v[188:191]
    v_add_u32 v242, s42, v242
    v_mfma_f32_16x16x32_bf16 v[188:191], v[164:167], v[64:67], v[188:191]
    v_mfma_f32_16x16x32_bf16 v[188:191], v[172:175], v[68:71], v[188:191]
    v_mfma_f32_16x16x32_bf16 v[180:183], v[172:175], v[64:67], v[180:183]
    v_mfma_f32_16x16x32_bf16 v[180:183], v[164:167], v[60:63], v[180:183]
    ds_read_b128 v[60:63], v240 offset:20544
    v_mfma_f32_16x16x32_bf16 v[180:183], v[156:159], v[56:59], v[180:183]
    ds_read_b128 v[56:59], v240 offset:20800
    v_mfma_f32_16x16x32_bf16 v[180:183], v[148:151], v[52:55], v[180:183]
    ds_read_b128 v[52:55], v240 offset:21056
    v_mfma_f32_16x16x32_bf16 v[180:183], v[140:143], v[48:51], v[180:183]
    ds_read_b128 v[48:51], v240 offset:21312
    s_waitcnt lgkmcnt(15)
    v_mfma_f32_16x16x32_bf16 v[176:179], v[96:99], v[40:43], v[176:179]
    v_mfma_f32_16x16x32_bf16 v[176:179], v[104:107], v[44:47], v[176:179]
    v_mfma_f32_16x16x32_bf16 v[176:179], v[112:115], v[248:251], v[176:179]
    v_mfma_f32_16x16x32_bf16 v[176:179], v[120:123], v[252:255], v[176:179]
    v_mfma_f32_16x16x32_bf16 v[176:179], v[128:131], v[88:91], v[176:179]
    s_waitcnt lgkmcnt(14)
    v_mfma_f32_16x16x32_bf16 v[184:187], v[128:131], v[92:95], v[184:187]
    v_mfma_f32_16x16x32_bf16 v[184:187], v[120:123], v[88:91], v[184:187]
    v_mfma_f32_16x16x32_bf16 v[184:187], v[112:115], v[252:255], v[184:187]
    v_mfma_f32_16x16x32_bf16 v[184:187], v[104:107], v[248:251], v[184:187]
    v_mfma_f32_16x16x32_bf16 v[184:187], v[96:99], v[44:47], v[184:187]
    s_waitcnt lgkmcnt(8)
    v_mfma_f32_16x16x32_bf16 v[188:191], v[100:103], v[44:47], v[188:191]
    v_mfma_f32_16x16x32_bf16 v[188:191], v[108:111], v[248:251], v[188:191]
    s_barrier
    v_mfma_f32_16x16x32_bf16 v[188:191], v[116:119], v[252:255], v[188:191]
    ds_read_b64_tr_b16 v[0:1], v241 offset:0
    ds_read_b64_tr_b16 v[2:3], v241 offset:1024
    s_waitcnt lgkmcnt(6)
    v_mfma_f32_16x16x32_bf16 v[188:191], v[124:127], v[88:91], v[188:191]
    ds_read_b64_tr_b16 v[8:9], v241 offset:8192
    ds_read_b64_tr_b16 v[10:11], v241 offset:9216
    v_mfma_f32_16x16x32_bf16 v[188:191], v[132:135], v[92:95], v[188:191]
    ds_read_b64_tr_b16 v[16:17], v241 offset:16384
    ds_read_b64_tr_b16 v[18:19], v241 offset:17408
    v_mfma_f32_16x16x32_bf16 v[180:183], v[132:135], v[88:91], v[180:183]
    ds_read_b64_tr_b16 v[24:25], v241 offset:24576
    ds_read_b64_tr_b16 v[26:27], v241 offset:25600
    v_mfma_f32_16x16x32_bf16 v[180:183], v[124:127], v[252:255], v[180:183]
    ds_read_b64_tr_b16 v[32:33], v241 offset:32768
    ds_read_b64_tr_b16 v[34:35], v241 offset:33792
    v_mfma_f32_16x16x32_bf16 v[180:183], v[116:119], v[248:251], v[180:183]
    v_mfma_f32_16x16x32_bf16 v[180:183], v[108:111], v[44:47], v[180:183]
    ds_read_b128 v[44:47], v240 offset:21584
    ds_read_b64_tr_b16 v[36:37], v242 offset:32768
    v_mfma_f32_16x16x32_bf16 v[180:183], v[100:103], v[40:43], v[180:183]
    ds_read_b64_tr_b16 v[38:39], v242 offset:33792
    ds_read_b64_tr_b16 v[28:29], v242 offset:24576
    s_waitcnt lgkmcnt(8)
    v_mfma_f32_16x16x32_bf16 v[176:179], v[0:3], v[60:63], v[176:179]
    ds_read_b64_tr_b16 v[30:31], v242 offset:25600
    ds_read_b64_tr_b16 v[20:21], v242 offset:16384
    v_mfma_f32_16x16x32_bf16 v[176:179], v[8:11], v[56:59], v[176:179]
    ds_read_b64_tr_b16 v[22:23], v242 offset:17408
    ds_read_b64_tr_b16 v[12:13], v242 offset:8192
    v_mfma_f32_16x16x32_bf16 v[176:179], v[16:19], v[52:55], v[176:179]
    ds_read_b64_tr_b16 v[14:15], v242 offset:9216
    ds_read_b64_tr_b16 v[4:5], v242 offset:0
    s_waitcnt lgkmcnt(12)
    v_mfma_f32_16x16x32_bf16 v[176:179], v[24:27], v[48:51], v[176:179]
    ds_read_b64_tr_b16 v[6:7], v242 offset:1024
    ds_read_b128 v[40:43], v240 offset:21840
    s_waitcnt lgkmcnt(11)
    v_mfma_f32_16x16x32_bf16 v[176:179], v[32:35], v[44:47], v[176:179]
    s_waitcnt lgkmcnt(9)
    v_mfma_f32_16x16x32_bf16 v[180:183], v[36:39], v[44:47], v[180:183]
    s_waitcnt lgkmcnt(7)
    v_mfma_f32_16x16x32_bf16 v[180:183], v[28:31], v[48:51], v[180:183]
    s_waitcnt lgkmcnt(5)
    v_mfma_f32_16x16x32_bf16 v[180:183], v[20:23], v[52:55], v[180:183]
    s_waitcnt lgkmcnt(3)
    v_mfma_f32_16x16x32_bf16 v[180:183], v[12:15], v[56:59], v[180:183]
    v_fma_f32 v176, s39, v176, v244
    v_fma_f32 v177, s39, v177, v244
    s_waitcnt lgkmcnt(1)
    v_mfma_f32_16x16x32_bf16 v[180:183], v[4:7], v[60:63], v[180:183]
    ds_read_b128 v[60:63], v240 offset:22032
    v_fma_f32 v178, s39, v178, v244
    v_fma_f32 v179, s39, v179, v244
    v_mfma_f32_16x16x32_bf16 v[184:187], v[0:3], v[56:59], v[184:187]
    v_exp_f32 v176, v176 clamp
    v_mfma_f32_16x16x32_bf16 v[184:187], v[8:11], v[52:55], v[184:187]
    v_exp_f32 v177, v177 clamp
    v_mfma_f32_16x16x32_bf16 v[184:187], v[16:19], v[48:51], v[184:187]
    v_exp_f32 v178, v178 clamp
    v_mfma_f32_16x16x32_bf16 v[184:187], v[24:27], v[44:47], v[184:187]
L_pad2:
    s_cbranch_vccnz L_padret0
    v_exp_f32 v179, v179 clamp
    s_waitcnt lgkmcnt(1)
    v_mfma_f32_16x16x32_bf16 v[184:187], v[32:35], v[40:43], v[184:187]
    v_fma_f32 v176, v176, s41, 0.5
    v_fma_f32 v177, v177, s41, 0.5
    v_mfma_f32_16x16x32_bf16 v[188:191], v[36:39], v[40:43], v[188:191]
    v_fma_f32 v178, v178, s41, 0.5
    v_fma_f32 v179, v179, s41, 0.5
    v_mfma_f32_16x16x32_bf16 v[188:191], v[28:31], v[44:47], v[188:191]
    v_mul_f32 v180, s40, v180
    v_mul_f32 v181, s40, v181
    v_mfma_f32_16x16x32_bf16 v[188:191], v[20:23], v[48:51], v[188:191]
    v_mul_f32 v182, s40, v182
    v_mul_f32 v183, s40, v183
    v_mfma_f32_16x16x32_bf16 v[188:191], v[12:15], v[52:55], v[188:191]
    v_exp_f32 v180, v180
    v_mfma_f32_16x16x32_bf16 v[188:191], v[4:7], v[56:59], v[188:191]
    ds_read_b128 v[56:59], v240 offset:22096
    v_exp_f32 v181, v181
    v_mfma_f32_16x16x32_bf16 v[192:195], v[96:99], v[248:251], v[192:195]
    v_exp_f32 v182, v182
    v_mfma_f32_16x16x32_bf16 v[192:195], v[104:107], v[252:255], v[192:195]
    v_exp_f32 v183, v183
    v_mfma_f32_16x16x32_bf16 v[192:195], v[112:115], v[88:91], v[192:195]
    v_fma_f32 v180, v176, v180, v176
    v_fma_f32 v181, v177, v181, v177
    v_mfma_f32_16x16x32_bf16 v[192:195], v[120:123], v[92:95], v[192:195]
    v_fma_f32 v182, v178, v182, v178
    v_fma_f32 v183, v179, v183, v179
    s_waitcnt lgkmcnt(1)
    v_mfma_f32_16x16x32_bf16 v[192:195], v[128:131], v[60:63], v[192:195]
    v_rcp_f32 v180, v180
    v_mfma_f32_16x16x32_bf16 v[192:195], v[0:3], v[52:55], v[192:195]
    v_rcp_f32 v181, v181
    v_mfma_f32_16x16x32_bf16 v[192:195], v[8:11], v[48:51], v[192:195]
    v_rcp_f32 v182, v182
    v_mfma_f32_16x16x32_bf16 v[192:195], v[16:19], v[44:47], v[192:195]
    v_rcp_f32 v183, v183
    v_mfma_f32_16x16x32_bf16 v[192:195], v[24:27], v[40:43], v[192:195]
    v_fma_f32 v180, -v176, v180, v180
    v_fma_f32 v181, -v177, v181, v181
    s_waitcnt lgkmcnt(0)
    v_mfma_f32_16x16x32_bf16 v[192:195], v[32:35], v[56:59], v[192:195]
    v_fma_f32 v182, -v178, v182, v182
    v_fma_f32 v183, -v179, v183, v183
    v_mfma_f32_16x16x32_bf16 v[196:199], v[100:103], v[248:251], v[196:199]
    ds_read_b128 v[248:251], v240 offset:22288
    v_cvt_pk_bf16_f32 v176, v180, v181
    v_cvt_pk_bf16_f32 v177, v182, v183
    v_mfma_f32_16x16x32_bf16 v[196:199], v[108:111], v[252:255], v[196:199]
    ds_write_b64 v243, v[176:177] offset:0
    v_fma_f32 v184, s39, v184, v244
    v_mfma_f32_16x16x32_bf16 v[196:199], v[116:119], v[88:91], v[196:199]
    ds_read_b128 v[180:183], v240 offset:22352
    v_fma_f32 v185, s39, v185, v244
    v_fma_f32 v186, s39, v186, v244
    v_mfma_f32_16x16x32_bf16 v[196:199], v[124:127], v[92:95], v[196:199]
    v_fma_f32 v187, s39, v187, v244
    v_mfma_f32_16x16x32_bf16 v[196:199], v[132:135], v[60:63], v[196:199]
    v_exp_f32 v184, v184 clamp
    v_mfma_f32_16x16x32_bf16 v[196:199], v[4:7], v[52:55], v[196:199]
    v_exp_f32 v185, v185 clamp
    v_mfma_f32_16x16x32_bf16 v[196:199], v[12:15], v[48:51], v[196:199]
    v_exp_f32 v186, v186 clamp
    v_mfma_f32_16x16x32_bf16 v[196:199], v[20:23], v[44:47], v[196:199]
    v_exp_f32 v187, v187 clamp
    v_mfma_f32_16x16x32_bf16 v[196:199], v[28:31], v[40:43], v[196:199]
    v_fma_f32 v184, v184, s41, 0.5
    v_fma_f32 v185, v185, s41, 0.5
    v_mfma_f32_16x16x32_bf16 v[196:199], v[36:39], v[56:59], v[196:199]
    ds_read_b128 v[176:179], v240 offset:22560
    v_fma_f32 v186, v186, s41, 0.5
    v_fma_f32 v187, v187, s41, 0.5
    v_mfma_f32_16x16x32_bf16 v[200:203], v[96:99], v[252:255], v[200:203]
    v_mul_f32 v188, s40, v188
    v_mul_f32 v189, s40, v189
    v_mfma_f32_16x16x32_bf16 v[200:203], v[104:107], v[88:91], v[200:203]
    v_mul_f32 v190, s40, v190
    v_mul_f32 v191, s40, v191
    v_mfma_f32_16x16x32_bf16 v[200:203], v[112:115], v[92:95], v[200:203]
    v_exp_f32 v188, v188
    v_mfma_f32_16x16x32_bf16 v[200:203], v[120:123], v[60:63], v[200:203]
    v_exp_f32 v189, v189
    s_waitcnt lgkmcnt(3)
    v_mfma_f32_16x16x32_bf16 v[200:203], v[128:131], v[248:251], v[200:203]
    ds_read_b128 v[52:55], v240 offset:22624
    v_exp_f32 v190, v190
    v_mfma_f32_16x16x32_bf16 v[200:203], v[0:3], v[48:51], v[200:203]
    v_exp_f32 v191, v191
    v_mfma_f32_16x16x32_bf16 v[200:203], v[8:11], v[44:47], v[200:203]
    v_fma_f32 v188, v184, v188, v184
    v_fma_f32 v189, v185, v189, v185
    v_mfma_f32_16x16x32_bf16 v[200:203], v[16:19], v[40:43], v[200:203]
    v_fma_f32 v190, v186, v190, v186
    v_fma_f32 v191, v187, v191, v187
    v_mfma_f32_16x16x32_bf16 v[200:203], v[24:27], v[56:59], v[200:203]
    v_rcp_f32 v188, v188
    s_waitcnt lgkmcnt(2)
    v_mfma_f32_16x16x32_bf16 v[200:203], v[32:35], v[180:183], v[200:203]
    v_rcp_f32 v189, v189
    v_mfma_f32_16x16x32_bf16 v[204:207], v[100:103], v[252:255], v[204:207]
    v_rcp_f32 v190, v190
    v_mfma_f32_16x16x32_bf16 v[204:207], v[108:111], v[88:91], v[204:207]
    v_rcp_f32 v191, v191
    v_mfma_f32_16x16x32_bf16 v[204:207], v[116:119], v[92:95], v[204:207]
    v_fma_f32 v188, -v184, v188, v188
    v_fma_f32 v189, -v185, v189, v189
    v_mfma_f32_16x16x32_bf16 v[204:207], v[124:127], v[60:63], v[204:207]
    v_fma_f32 v190, -v186, v190, v190
    v_fma_f32 v191, -v187, v191, v191
    v_mfma_f32_16x16x32_bf16 v[204:207], v[132:135], v[248:251], v[204:207]
    v_cvt_pk_bf16_f32 v184, v188, v189
    v_cvt_pk_bf16_f32 v185, v190, v191
    v_mfma_f32_16x16x32_bf16 v[204:207], v[4:7], v[48:51], v[204:207]
    ds_write_b64 v243, v[184:185] offset:256
    v_fma_f32 v192, s39, v192, v244
    v_mfma_f32_16x16x32_bf16 v[204:207], v[12:15], v[44:47], v[204:207]
    v_fma_f32 v193, s39, v193, v244
    v_fma_f32 v194, s39, v194, v244
    v_mfma_f32_16x16x32_bf16 v[204:207], v[20:23], v[40:43], v[204:207]
    v_fma_f32 v195, s39, v195, v244
    v_mfma_f32_16x16x32_bf16 v[204:207], v[28:31], v[56:59], v[204:207]
    v_exp_f32 v192, v192 clamp
    v_mfma_f32_16x16x32_bf16 v[204:207], v[36:39], v[180:183], v[204:207]
    v_exp_f32 v193, v193 clamp
    v_mfma_f32_16x16x32_bf16 v[208:211], v[136:139], v[64:67], v[208:211]
    s_waitcnt lgkmcnt(0)
    s_barrier
    v_mfma_f32_16x16x32_bf16 v[208:211], v[144:147], v[68:71], v[208:211]
    v_exp_f32 v194, v194 clamp
    v_mfma_f32_16x16x32_bf16 v[208:211], v[152:155], v[72:75], v[208:211]
    v_exp_f32 v195, v195 clamp
    v_mfma_f32_16x16x32_bf16 v[208:211], v[160:163], v[76:79], v[208:211]
    v_fma_f32 v192, v192, s41, 0.5
    v_fma_f32 v193, v193, s41, 0.5
    v_mfma_f32_16x16x32_bf16 v[208:211], v[168:171], v[80:83], v[208:211]
    v_fma_f32 v194, v194, s41, 0.5
    v_fma_f32 v195, v195, s41, 0.5
    v_mfma_f32_16x16x32_bf16 v[208:211], v[96:99], v[88:91], v[208:211]
    v_mul_f32 v196, s40, v196
    v_mul_f32 v197, s40, v197
    v_mfma_f32_16x16x32_bf16 v[208:211], v[104:107], v[92:95], v[208:211]
    v_mul_f32 v198, s40, v198
    v_mul_f32 v199, s40, v199
    v_mfma_f32_16x16x32_bf16 v[208:211], v[112:115], v[60:63], v[208:211]
    v_exp_f32 v196, v196
    v_mfma_f32_16x16x32_bf16 v[208:211], v[120:123], v[248:251], v[208:211]
    v_exp_f32 v197, v197
    v_mfma_f32_16x16x32_bf16 v[208:211], v[128:131], v[176:179], v[208:211]
    ds_read_b128 v[252:255], v240 offset:22816
    v_exp_f32 v198, v198
    v_mfma_f32_16x16x32_bf16 v[208:211], v[0:3], v[44:47], v[208:211]
    v_exp_f32 v199, v199
    v_mfma_f32_16x16x32_bf16 v[208:211], v[8:11], v[40:43], v[208:211]
    v_fma_f32 v196, v192, v196, v192
    v_fma_f32 v197, v193, v197, v193
    v_mfma_f32_16x16x32_bf16 v[208:211], v[16:19], v[56:59], v[208:211]
    v_fma_f32 v198, v194, v198, v194
    v_fma_f32 v199, v195, v199, v195
    v_mfma_f32_16x16x32_bf16 v[208:211], v[24:27], v[180:183], v[208:211]
    v_rcp_f32 v196, v196
    v_mfma_f32_16x16x32_bf16 v[208:211], v[32:35], v[52:55], v[208:211]
    ds_read_b128 v[48:51], v240 offset:22880
    v_rcp_f32 v197, v197
    v_mfma_f32_16x16x32_bf16 v[212:215], v[140:143], v[64:67], v[212:215]
    v_rcp_f32 v198, v198
    v_mfma_f32_16x16x32_bf16 v[212:215], v[148:151], v[68:71], v[212:215]
    v_rcp_f32 v199, v199
    v_mfma_f32_16x16x32_bf16 v[212:215], v[156:159], v[72:75], v[212:215]
    v_fma_f32 v196, -v192, v196, v196
    v_fma_f32 v197, -v193, v197, v197
    v_mfma_f32_16x16x32_bf16 v[212:215], v[164:167], v[76:79], v[212:215]
    v_fma_f32 v198, -v194, v198, v198
    v_fma_f32 v199, -v195, v199, v199
    v_mfma_f32_16x16x32_bf16 v[212:215], v[172:175], v[80:83], v[212:215]
    v_cvt_pk_bf16_f32 v192, v196, v197
    v_cvt_pk_bf16_f32 v193, v198, v199
    v_mfma_f32_16x16x32_bf16 v[212:215], v[100:103], v[88:91], v[212:215]
    ds_write_b64 v243, v[192:193] offset:512
    v_fma_f32 v200, s39, v200, v244
    v_mfma_f32_16x16x32_bf16 v[212:215], v[108:111], v[92:95], v[212:215]
    v_fma_f32 v201, s39, v201, v244
    v_fma_f32 v202, s39, v202, v244
    v_mfma_f32_16x16x32_bf16 v[212:215], v[116:119], v[60:63], v[212:215]
    v_fma_f32 v203, s39, v203, v244
    v_mfma_f32_16x16x32_bf16 v[212:215], v[124:127], v[248:251], v[212:215]
    v_exp_f32 v200, v200 clamp
    v_mfma_f32_16x16x32_bf16 v[212:215], v[132:135], v[176:179], v[212:215]
    v_exp_f32 v201, v201 clamp
    v_mfma_f32_16x16x32_bf16 v[212:215], v[4:7], v[44:47], v[212:215]
    v_exp_f32 v202, v202 clamp
    v_mfma_f32_16x16x32_bf16 v[212:215], v[12:15], v[40:43], v[212:215]
    v_exp_f32 v203, v203 clamp
    v_mfma_f32_16x16x32_bf16 v[212:215], v[20:23], v[56:59], v[212:215]
    v_fma_f32 v200, v200, s41, 0.5
    v_fma_f32 v201, v201, s41, 0.5
    v_mfma_f32_16x16x32_bf16 v[212:215], v[28:31], v[180:183], v[212:215]
    v_fma_f32 v202, v202, s41, 0.5
    v_fma_f32 v203, v203, s41, 0.5
    v_mfma_f32_16x16x32_bf16 v[212:215], v[36:39], v[52:55], v[212:215]
    v_mul_f32 v204, s40, v204
    v_mul_f32 v205, s40, v205
    v_mfma_f32_16x16x32_bf16 v[216:219], v[136:139], v[68:71], v[216:219]
    v_mul_f32 v206, s40, v206
    v_mul_f32 v207, s40, v207
    v_mfma_f32_16x16x32_bf16 v[216:219], v[144:147], v[72:75], v[216:219]
    v_exp_f32 v204, v204
    v_mfma_f32_16x16x32_bf16 v[216:219], v[152:155], v[76:79], v[216:219]
    v_exp_f32 v205, v205
    v_mfma_f32_16x16x32_bf16 v[216:219], v[160:163], v[80:83], v[216:219]
    v_exp_f32 v206, v206
    v_mfma_f32_16x16x32_bf16 v[216:219], v[168:171], v[84:87], v[216:219]
    ds_read_b128 v[188:191], v240 offset:2656
    v_exp_f32 v207, v207
    v_mfma_f32_16x16x32_bf16 v[216:219], v[96:99], v[92:95], v[216:219]
    v_fma_f32 v204, v200, v204, v200
    v_fma_f32 v205, v201, v205, v201
    v_mfma_f32_16x16x32_bf16 v[216:219], v[104:107], v[60:63], v[216:219]
    v_fma_f32 v206, v202, v206, v202
    v_fma_f32 v207, v203, v207, v203
    v_mfma_f32_16x16x32_bf16 v[216:219], v[112:115], v[248:251], v[216:219]
    v_rcp_f32 v204, v204
    v_mfma_f32_16x16x32_bf16 v[216:219], v[120:123], v[176:179], v[216:219]
    v_rcp_f32 v205, v205
    s_waitcnt lgkmcnt(3)
    v_mfma_f32_16x16x32_bf16 v[216:219], v[128:131], v[252:255], v[216:219]
    ds_read_b128 v[184:187], v240 offset:23072
    v_rcp_f32 v206, v206
    v_mfma_f32_16x16x32_bf16 v[216:219], v[0:3], v[40:43], v[216:219]
    v_rcp_f32 v207, v207
    v_mfma_f32_16x16x32_bf16 v[216:219], v[8:11], v[56:59], v[216:219]
    v_fma_f32 v204, -v200, v204, v204
    v_fma_f32 v205, -v201, v205, v205
    v_mfma_f32_16x16x32_bf16 v[216:219], v[16:19], v[180:183], v[216:219]
    v_fma_f32 v206, -v202, v206, v206
    v_fma_f32 v207, -v203, v207, v207
    v_mfma_f32_16x16x32_bf16 v[216:219], v[24:27], v[52:55], v[216:219]
    v_cvt_pk_bf16_f32 v200, v204, v205
    v_cvt_pk_bf16_f32 v201, v206, v207
    s_waitcnt lgkmcnt(3)
    v_mfma_f32_16x16x32_bf16 v[216:219], v[32:35], v[48:51], v[216:219]
    ds_read_b128 v[64:67], v240 offset:23136
    ds_write_b64 v243, v[200:201] offset:768
    v_fma_f32 v208, s39, v208, v244
    v_mfma_f32_16x16x32_bf16 v[220:223], v[140:143], v[68:71], v[220:223]
    v_fma_f32 v209, s39, v209, v244
    v_fma_f32 v210, s39, v210, v244
    v_mfma_f32_16x16x32_bf16 v[220:223], v[148:151], v[72:75], v[220:223]
    v_fma_f32 v211, s39, v211, v244
    v_mfma_f32_16x16x32_bf16 v[220:223], v[156:159], v[76:79], v[220:223]
    v_exp_f32 v208, v208 clamp
    v_mfma_f32_16x16x32_bf16 v[220:223], v[164:167], v[80:83], v[220:223]
    v_exp_f32 v209, v209 clamp
    v_mfma_f32_16x16x32_bf16 v[220:223], v[172:175], v[84:87], v[220:223]
    s_waitcnt lgkmcnt(0)
    s_barrier
    v_mfma_f32_16x16x32_bf16 v[220:223], v[100:103], v[92:95], v[220:223]
    v_exp_f32 v210, v210 clamp
    v_mfma_f32_16x16x32_bf16 v[220:223], v[108:111], v[60:63], v[220:223]
    v_exp_f32 v211, v211 clamp
    v_mfma_f32_16x16x32_bf16 v[220:223], v[116:119], v[248:251], v[220:223]
    v_fma_f32 v208, v208, s41, 0.5
    v_fma_f32 v209, v209, s41, 0.5
    v_mfma_f32_16x16x32_bf16 v[220:223], v[124:127], v[176:179], v[220:223]
    v_fma_f32 v210, v210, s41, 0.5
    v_fma_f32 v211, v211, s41, 0.5
    v_mfma_f32_16x16x32_bf16 v[220:223], v[132:135], v[252:255], v[220:223]
    v_mul_f32 v212, s40, v212
    v_mul_f32 v213, s40, v213
    v_mfma_f32_16x16x32_bf16 v[220:223], v[4:7], v[40:43], v[220:223]
    v_mul_f32 v214, s40, v214
    v_mul_f32 v215, s40, v215
    v_mfma_f32_16x16x32_bf16 v[220:223], v[12:15], v[56:59], v[220:223]
    v_exp_f32 v212, v212
    v_mfma_f32_16x16x32_bf16 v[220:223], v[20:23], v[180:183], v[220:223]
    v_exp_f32 v213, v213
    v_mfma_f32_16x16x32_bf16 v[220:223], v[28:31], v[52:55], v[220:223]
    v_exp_f32 v214, v214
    v_mfma_f32_16x16x32_bf16 v[220:223], v[36:39], v[48:51], v[220:223]
    v_exp_f32 v215, v215
    v_mfma_f32_16x16x32_bf16 v[224:227], v[136:139], v[72:75], v[224:227]
    v_fma_f32 v212, v208, v212, v208
    v_fma_f32 v213, v209, v213, v209
    v_mfma_f32_16x16x32_bf16 v[224:227], v[144:147], v[76:79], v[224:227]
    v_fma_f32 v214, v210, v214, v210
    v_fma_f32 v215, v211, v215, v211
    v_mfma_f32_16x16x32_bf16 v[224:227], v[152:155], v[80:83], v[224:227]
    v_rcp_f32 v212, v212
    v_mfma_f32_16x16x32_bf16 v[224:227], v[160:163], v[84:87], v[224:227]
    v_rcp_f32 v213, v213
    v_mfma_f32_16x16x32_bf16 v[224:227], v[168:171], v[188:191], v[224:227]
    ds_read_b128 v[88:91], v240 offset:2912
    v_rcp_f32 v214, v214
    v_mfma_f32_16x16x32_bf16 v[224:227], v[96:99], v[60:63], v[224:227]
    v_rcp_f32 v215, v215
    v_mfma_f32_16x16x32_bf16 v[224:227], v[104:107], v[248:251], v[224:227]
    v_fma_f32 v212, -v208, v212, v212
    v_fma_f32 v213, -v209, v213, v213
    v_mfma_f32_16x16x32_bf16 v[224:227], v[112:115], v[176:179], v[224:227]
    v_fma_f32 v214, -v210, v214, v214
    v_fma_f32 v215, -v211, v215, v215
    v_mfma_f32_16x16x32_bf16 v[224:227], v[120:123], v[252:255], v[224:227]
    v_cvt_pk_bf16_f32 v208, v212, v213
    v_cvt_pk_bf16_f32 v209, v214, v215
    v_mfma_f32_16x16x32_bf16 v[224:227], v[128:131], v[184:187], v[224:227]
    ds_read_b128 v[196:199], v240 offset:23328
    ds_write_b64 v243, v[208:209] offset:1024
    v_fma_f32 v216, s39, v216, v244
    v_mfma_f32_16x16x32_bf16 v[224:227], v[0:3], v[56:59], v[224:227]
    v_fma_f32 v217, s39, v217, v244
    v_fma_f32 v218, s39, v218, v244
    v_mfma_f32_16x16x32_bf16 v[224:227], v[8:11], v[180:183], v[224:227]
    v_fma_f32 v219, s39, v219, v244
    v_mfma_f32_16x16x32_bf16 v[224:227], v[16:19], v[52:55], v[224:227]
    v_exp_f32 v216, v216 clamp
    v_mfma_f32_16x16x32_bf16 v[224:227], v[24:27], v[48:51], v[224:227]
    v_exp_f32 v217, v217 clamp
    v_mfma_f32_16x16x32_bf16 v[224:227], v[32:35], v[64:67], v[224:227]
    ds_read_b128 v[192:195], v240 offset:23392
    v_exp_f32 v218, v218 clamp
    v_mfma_f32_16x16x32_bf16 v[228:231], v[140:143], v[72:75], v[228:231]
    v_exp_f32 v219, v219 clamp
    v_mfma_f32_16x16x32_bf16 v[228:231], v[148:151], v[76:79], v[228:231]
    v_fma_f32 v216, v216, s41, 0.5
    v_fma_f32 v217, v217, s41, 0.5
    v_mfma_f32_16x16x32_bf16 v[228:231], v[156:159], v[80:83], v[228:231]
    v_fma_f32 v218, v218, s41, 0.5
    v_fma_f32 v219, v219, s41, 0.5
    v_mfma_f32_16x16x32_bf16 v[228:231], v[164:167], v[84:87], v[228:231]
    v_mul_f32 v220, s40, v220
    v_mul_f32 v221, s40, v221
    v_mfma_f32_16x16x32_bf16 v[228:231], v[172:175], v[188:191], v[228:231]
    v_mul_f32 v222, s40, v222
    v_mul_f32 v223, s40, v223
    v_mfma_f32_16x16x32_bf16 v[228:231], v[100:103], v[60:63], v[228:231]
    v_exp_f32 v220, v220
    v_mfma_f32_16x16x32_bf16 v[228:231], v[108:111], v[248:251], v[228:231]
    v_exp_f32 v221, v221
    v_mfma_f32_16x16x32_bf16 v[228:231], v[116:119], v[176:179], v[228:231]
    v_exp_f32 v222, v222
    v_mfma_f32_16x16x32_bf16 v[228:231], v[124:127], v[252:255], v[228:231]
    v_exp_f32 v223, v223
    v_mfma_f32_16x16x32_bf16 v[228:231], v[132:135], v[184:187], v[228:231]
    v_fma_f32 v220, v216, v220, v216
    v_fma_f32 v221, v217, v221, v217
    v_mfma_f32_16x16x32_bf16 v[228:231], v[4:7], v[56:59], v[228:231]
    v_fma_f32 v222, v218, v222, v218
    v_fma_f32 v223, v219, v223, v219
    v_mfma_f32_16x16x32_bf16 v[228:231], v[12:15], v[180:183], v[228:231]
    v_rcp_f32 v220, v220
    v_mfma_f32_16x16x32_bf16 v[228:231], v[20:23], v[52:55], v[228:231]
    v_rcp_f32 v221, v221
    v_mfma_f32_16x16x32_bf16 v[228:231], v[28:31], v[48:51], v[228:231]
    v_rcp_f32 v222, v222
    v_mfma_f32_16x16x32_bf16 v[228:231], v[36:39], v[64:67], v[228:231]
    v_rcp_f32 v223, v223
    v_mfma_f32_16x16x32_bf16 v[232:235], v[136:139], v[76:79], v[232:235]
    v_fma_f32 v220, -v216, v220, v220
    v_fma_f32 v221, -v217, v221, v221
    v_mfma_f32_16x16x32_bf16 v[232:235], v[144:147], v[80:83], v[232:235]
    v_fma_f32 v222, -v218, v222, v222
    v_fma_f32 v223, -v219, v223, v223
    v_mfma_f32_16x16x32_bf16 v[232:235], v[152:155], v[84:87], v[232:235]
    v_cvt_pk_bf16_f32 v216, v220, v221
    v_cvt_pk_bf16_f32 v217, v222, v223
    v_mfma_f32_16x16x32_bf16 v[232:235], v[160:163], v[188:191], v[232:235]
    ds_write_b64 v243, v[216:217] offset:1280
    v_fma_f32 v224, s39, v224, v244
    s_waitcnt lgkmcnt(4)
    v_mfma_f32_16x16x32_bf16 v[232:235], v[168:171], v[88:91], v[232:235]
    v_fma_f32 v225, s39, v225, v244
    v_fma_f32 v226, s39, v226, v244
    v_mfma_f32_16x16x32_bf16 v[232:235], v[96:99], v[248:251], v[232:235]
    v_fma_f32 v227, s39, v227, v244
    v_mfma_f32_16x16x32_bf16 v[232:235], v[104:107], v[176:179], v[232:235]
    v_exp_f32 v224, v224 clamp
    v_mfma_f32_16x16x32_bf16 v[232:235], v[112:115], v[252:255], v[232:235]
    v_exp_f32 v225, v225 clamp
    v_mfma_f32_16x16x32_bf16 v[232:235], v[120:123], v[184:187], v[232:235]
    s_waitcnt lgkmcnt(0)
    s_barrier
    v_mfma_f32_16x16x32_bf16 v[232:235], v[128:131], v[196:199], v[232:235]
    v_exp_f32 v226, v226 clamp
    v_mfma_f32_16x16x32_bf16 v[232:235], v[0:3], v[180:183], v[232:235]
    v_exp_f32 v227, v227 clamp
    v_mfma_f32_16x16x32_bf16 v[232:235], v[8:11], v[52:55], v[232:235]
    v_fma_f32 v224, v224, s41, 0.5
    v_fma_f32 v225, v225, s41, 0.5
    v_mfma_f32_16x16x32_bf16 v[232:235], v[16:19], v[48:51], v[232:235]
    v_fma_f32 v226, v226, s41, 0.5
    v_fma_f32 v227, v227, s41, 0.5
    v_mfma_f32_16x16x32_bf16 v[232:235], v[24:27], v[64:67], v[232:235]
    v_mul_f32 v228, s40, v228
    v_mul_f32 v229, s40, v229
    v_mfma_f32_16x16x32_bf16 v[232:235], v[32:35], v[192:195], v[232:235]
    v_mul_f32 v230, s40, v230
    v_mul_f32 v231, s40, v231
    v_mfma_f32_16x16x32_bf16 v[236:239], v[140:143], v[76:79], v[236:239]
    v_exp_f32 v228, v228
    v_mfma_f32_16x16x32_bf16 v[236:239], v[148:151], v[80:83], v[236:239]
    v_exp_f32 v229, v229
    v_mfma_f32_16x16x32_bf16 v[236:239], v[156:159], v[84:87], v[236:239]
    v_exp_f32 v230, v230
    v_mfma_f32_16x16x32_bf16 v[236:239], v[164:167], v[188:191], v[236:239]
    v_exp_f32 v231, v231
    v_mfma_f32_16x16x32_bf16 v[236:239], v[172:175], v[88:91], v[236:239]
    v_fma_f32 v228, v224, v228, v224
    v_fma_f32 v229, v225, v229, v225
    v_mfma_f32_16x16x32_bf16 v[236:239], v[100:103], v[248:251], v[236:239]
    v_fma_f32 v230, v226, v230, v226
    v_fma_f32 v231, v227, v231, v227
    v_mfma_f32_16x16x32_bf16 v[236:239], v[108:111], v[176:179], v[236:239]
    v_rcp_f32 v228, v228
    v_mfma_f32_16x16x32_bf16 v[236:239], v[116:119], v[252:255], v[236:239]
    v_rcp_f32 v229, v229
    v_mfma_f32_16x16x32_bf16 v[236:239], v[124:127], v[184:187], v[236:239]
    v_rcp_f32 v230, v230
    v_mfma_f32_16x16x32_bf16 v[236:239], v[132:135], v[196:199], v[236:239]
    v_rcp_f32 v231, v231
    v_mfma_f32_16x16x32_bf16 v[236:239], v[4:7], v[180:183], v[236:239]
    v_fma_f32 v228, -v224, v228, v228
    v_fma_f32 v229, -v225, v229, v229
    v_mfma_f32_16x16x32_bf16 v[236:239], v[12:15], v[52:55], v[236:239]
    v_fma_f32 v230, -v226, v230, v230
    v_fma_f32 v231, -v227, v231, v231
    v_mfma_f32_16x16x32_bf16 v[236:239], v[20:23], v[48:51], v[236:239]
    v_cvt_pk_bf16_f32 v224, v228, v229
    v_cvt_pk_bf16_f32 v225, v230, v231
    v_mfma_f32_16x16x32_bf16 v[236:239], v[28:31], v[64:67], v[236:239]
    ds_write_b64 v243, v[224:225] offset:1536
    v_fma_f32 v232, s39, v232, v244
    v_mfma_f32_16x16x32_bf16 v[236:239], v[36:39], v[192:195], v[236:239]
    v_fma_f32 v233, s39, v233, v244
    v_fma_f32 v234, s39, v234, v244
    v_fma_f32 v235, s39, v235, v244
    v_exp_f32 v232, v232 clamp
    v_exp_f32 v233, v233 clamp
    v_exp_f32 v234, v234 clamp
    v_exp_f32 v235, v235 clamp
    v_pk_fma_f32 v[232:233], v[232:233], s[34:35], 0.5 op_sel_hi:[1,1,0]
    v_pk_fma_f32 v[234:235], v[234:235], s[34:35], 0.5 op_sel_hi:[1,1,0]
    v_pk_mul_f32 v[236:237], v[236:237], s[32:33]
    v_pk_mul_f32 v[238:239], v[238:239], s[32:33]
    v_exp_f32 v236, v236
    v_exp_f32 v237, v237
    v_exp_f32 v238, v238
    v_exp_f32 v239, v239
    v_pk_fma_f32 v[236:237], v[232:233], v[236:237], v[232:233]
    v_pk_fma_f32 v[238:239], v[234:235], v[238:239], v[234:235]
    v_rcp_f32 v236, v236
    v_rcp_f32 v237, v237
    v_rcp_f32 v238, v238
    v_rcp_f32 v239, v239
    v_pk_fma_f32 v[236:237], v[232:233], v[236:237], v[236:237] neg_lo:[1,0,0] neg_hi:[1,0,0]
    v_pk_fma_f32 v[238:239], v[234:235], v[238:239], v[238:239] neg_lo:[1,0,0] neg_hi:[1,0,0]
    v_cvt_pk_bf16_f32 v232, v236, v237
    v_cvt_pk_bf16_f32 v233, v238, v239
    ds_write_b64 v243, v[232:233] offset:1792
    s_waitcnt lgkmcnt(0)
    s_barrier
L_end:
    s_endpgm
L_cend:

.section .rodata,"a"
.p2align 6
.amdhsa_kernel standalone__autoregressive_conv_wavernn__speech_kernel
  .amdhsa_next_free_vgpr 256
  .amdhsa_next_free_sgpr 96
  .amdhsa_accum_offset 256
  .amdhsa_group_segment_fixed_size 0
  .amdhsa_kernarg_size 40
  .amdhsa_user_sgpr_count 2
  .amdhsa_user_sgpr_kernarg_segment_ptr 1
  .amdhsa_system_sgpr_workgroup_id_x 1
.end_amdhsa_kernel
```
